```python
import torch

def _softmax(x, axis=-1):
    return torch.softmax(x, dim=axis)
def _gelu(x):
    return torch.nn.functional.gelu(x, approximate="tanh")
def _silu(x):
    return torch.nn.functional.silu(x)
def _sigmoid(x):
    return torch.sigmoid(x)
def _layernorm(x, axis=-1, eps=1e-5):
    m = x.mean(dim=axis, keepdim=True)
    v = x.var(dim=axis, keepdim=True, unbiased=False)
    return (x - m) / torch.sqrt(v + eps)
def _scatter_add(tgt, idx, src, axis=0):
    return tgt.clone().index_add_(axis, idx, src)
def _segment_sum(src, seg, n):
    out = torch.zeros((n,) + src.shape[1:], dtype=src.dtype)
    return out.index_add_(0, seg, src)
def _pad(x, pw):
    flat = tuple(v for pair in reversed(pw) for v in pair)
    return torch.nn.functional.pad(x, flat)

kernel_name = 'parallel_sum__mha_block_cached__dense_activation_squared_relu__decode'

def setup_inputs():

    _w = (lambda a: (lambda t: t.to(torch.bfloat16) if t.is_floating_point() else t)(torch.as_tensor(a)))
    def _A_setup():
        B, Sq, D = 1, 1, 512
        H, Sk, Dh = 32, 65536, 128
        return {
            "x": _w((lambda *s: torch.randn(*s, dtype=torch.bfloat16) * 0.05)(B, Sq, D)),
            "k_cache": _w((lambda *s: torch.randn(*s, dtype=torch.bfloat16) * 3.2)(B, H, Sk, Dh)),
            "v_cache": _w((lambda *s: torch.randn(*s, dtype=torch.bfloat16) * 1.6)(B, H, Sk, Dh)),
            "wq": _w((lambda *s: torch.randn(*s, dtype=torch.bfloat16) * 3.2)(D, H * Dh) * (D ** -0.5)),
            "wo": _w((lambda *s: torch.randn(*s, dtype=torch.bfloat16) * 1.6)(H * Dh, D) * ((H * Dh) ** -0.5)),
        }
    _A_in = _A_setup()

    def _B_setup():
        B, S, D, F = 1, 1, 512, 1792
        return {
            "x": _w((lambda *s: torch.randn(*s, dtype=torch.bfloat16) * 0.05)(B, S, D)),
            "w1": _w((lambda *s: torch.randn(*s, dtype=torch.bfloat16) * 0.05)(D, F)),
            "b1": _w((lambda *s: torch.randn(*s, dtype=torch.bfloat16) * 0.05)(F)),
            "w2": _w((lambda *s: torch.randn(*s, dtype=torch.bfloat16) * 0.05)(F, D)),
            "b2": _w((lambda *s: torch.randn(*s, dtype=torch.bfloat16) * 0.05)(D)),
        }
    _B_in = _B_setup()

    return {
        "A_x": _A_in["x"],
        "A_k_cache": _A_in["k_cache"],
        "A_v_cache": _A_in["v_cache"],
        "A_wq": _A_in["wq"],
        "A_wo": _A_in["wo"],
        "B_x": _B_in["x"],
        "B_w1": _B_in["w1"],
        "B_b1": _B_in["b1"],
        "B_w2": _B_in["w2"],
        "B_b2": _B_in["b2"],
    }

def reference(A_x, A_k_cache, A_v_cache, A_wq, A_wo, B_x, B_w1, B_b1, B_w2, B_b2):
    def _A_ref(x, k_cache, v_cache, wq, wo):
        B, Sq, D = x.shape
        H, Dh = 32, 128
        q = (lambda x, *d: x.permute(*d))((x @ wq).reshape(B, Sq, H, Dh), 0, 2, 1, 3)
        scores = torch.einsum("bhqd,bhkd->bhqk", q, k_cache) * (Dh ** -0.5)
        p = _softmax(scores, axis=-1)
        o = torch.einsum("bhqk,bhkd->bhqd", p, v_cache)
        return (lambda x, *d: x.permute(*d))(o, 0, 2, 1, 3).reshape(B, Sq, H * Dh) @ wo

    def _B_ref(x, w1, b1, w2, b2):
        h = torch.einsum("bsd,df->bsf", x, w1) + b1
        zero = torch.zeros_like(h)
        r = torch.where(h > zero, h, zero)
        h = r * r
        out = torch.einsum("bsf,fd->bsd", h, w2) + b2
        return out

    x = A_x
    xn = _layernorm(x, axis=-1)
    return x + _A_ref(xn, A_k_cache, A_v_cache, A_wq, A_wo) + _B_ref(xn, B_w1, B_b1, B_w2, B_b2)
```

```asm
; @launch grid=(256,1,1) block=(384,1,1) lds=154880
.amdgcn_target "amdgcn-amd-amdhsa--gfx950"
.text
.globl parallel_sum__mha_block_cached__dense_activation_squared_relu__decode_kernel
.p2align 8
.type parallel_sum__mha_block_cached__dense_activation_squared_relu__decode_kernel,@function
parallel_sum__mha_block_cached__dense_activation_squared_relu__decode_kernel:
  s_cmp_ge_u32 s2, 256
  s_cbranch_scc1 L_end
  s_load_dwordx16 s[16:31], s[0:1], 0
  s_load_dwordx8 s[32:39], s[0:1], 64
  s_load_dwordx2 s[40:41], s[0:1], 96
  v_lshrrev_b32 v1, 6, v0
  v_and_b32 v0, 63, v0
  v_lshlrev_b32 v2, 4, v0
  v_readfirstlane_b32 s3, v1
  s_and_b32 s4, s2, 7
  s_lshl_b32 s4, s4, 2
  s_lshr_b32 s5, s2, 3
  s_and_b32 s5, s5, 3
  s_add_u32 s4, s4, s5
  s_lshr_b32 s5, s2, 5
  s_lshl_b32 s7, s4, 3
  s_add_u32 s7, s7, s5
  s_mov_b32 s98, 0x200000
  s_cmp_lg_u32 s3, 0
  s_waitcnt lgkmcnt(0)
  s_cbranch_scc1 L_notloader
  s_lshl_b32 s42, s4, 24
  s_lshr_b32 s43, s4, 8
  s_mul_i32 s53, s4, 524288
  s_mul_i32 s52, s5, 16384
  s_add_u32 s53, s53, s52
  s_and_b32 s53, s53, 0xffffff
  s_mov_b32 s10, 0x1000000
  s_add_u32 s8, s18, s42
  s_addc_u32 s9, s19, s43
  s_mov_b32 s11, 0x20000
  s_mov_b32 s51, 0
  s_mov_b32 s52, s53
  s_add_u32 m0, s51, 0
  s_nop 0
  buffer_load_dwordx4 v2, s[8:11], s52 offen offset:0 nt lds
  buffer_load_dwordx4 v2, s[8:11], s52 offen offset:1024 nt lds
  buffer_load_dwordx4 v2, s[8:11], s52 offen offset:2048 nt lds
  buffer_load_dwordx4 v2, s[8:11], s52 offen offset:3072 nt lds
  s_add_u32 s52, s52, 4096
  s_add_u32 m0, s51, 4096
  s_nop 0
  buffer_load_dwordx4 v2, s[8:11], s52 offen offset:0 nt lds
  buffer_load_dwordx4 v2, s[8:11], s52 offen offset:1024 nt lds
  buffer_load_dwordx4 v2, s[8:11], s52 offen offset:2048 nt lds
  buffer_load_dwordx4 v2, s[8:11], s52 offen offset:3072 nt lds
  s_add_u32 s52, s52, 4096
  s_add_u32 m0, s51, 8192
  s_nop 0
  buffer_load_dwordx4 v2, s[8:11], s52 offen offset:0 nt lds
  buffer_load_dwordx4 v2, s[8:11], s52 offen offset:1024 nt lds
  buffer_load_dwordx4 v2, s[8:11], s52 offen offset:2048 nt lds
  buffer_load_dwordx4 v2, s[8:11], s52 offen offset:3072 nt lds
  s_add_u32 s52, s52, 4096
  s_add_u32 m0, s51, 12288
  s_nop 0
  buffer_load_dwordx4 v2, s[8:11], s52 offen offset:0 nt lds
  buffer_load_dwordx4 v2, s[8:11], s52 offen offset:1024 nt lds
  buffer_load_dwordx4 v2, s[8:11], s52 offen offset:2048 nt lds
  buffer_load_dwordx4 v2, s[8:11], s52 offen offset:3072 nt lds
  s_add_u32 s52, s52, 4096
  s_setprio 3
  s_add_u32 s12, s20, s42
  s_addc_u32 s13, s21, s43
  s_mov_b32 s50, 0
  s_mov_b32 s54, 0
  v_mov_b32 v4, 131072
  s_add_u32 s50, s50, 1
  s_add_u32 s51, s51, 16384
  s_and_b32 s51, s51, 131071
  s_add_u32 s52, s52, 114688
  s_and_b32 s52, s52, 0xffffff
  s_barrier
  s_add_u32 s55, s50, 0
  s_and_b32 s55, s55, 7
  s_lshl_b32 s55, s55, 2
  s_add_u32 s55, s55, 131104
  v_mov_b32 v5, s55
  ds_read_b32 v6, v5
  v_mov_b32 v7, 0
L_ld_loop:
  s_waitcnt lgkmcnt(0)
  v_readfirstlane_b32 s56, v6
  v_readfirstlane_b32 s57, v7
  s_lshr_b32 s55, s50, 3
  s_cmp_ge_u32 s56, s55
  s_cbranch_scc0 L_ld_slow
L_ld_go:
  s_cmp_lt_u32 s50, 10
  s_cbranch_scc1 L_ld_wB
  s_cmp_lg_u32 s57, 0
  s_cbranch_scc1 L_ld_sel
  s_cmp_ge_u32 s50, 250
  s_cbranch_scc1 L_ld_wB
  s_add_u32 m0, s51, 0
  s_waitcnt vmcnt(19)
  buffer_load_dwordx4 v2, s[8:11], s52 offen offset:0 nt lds
  s_waitcnt vmcnt(19)
  buffer_load_dwordx4 v2, s[8:11], s52 offen offset:1024 nt lds
  s_waitcnt vmcnt(19)
  buffer_load_dwordx4 v2, s[8:11], s52 offen offset:2048 nt lds
  s_waitcnt vmcnt(19)
  buffer_load_dwordx4 v2, s[8:11], s52 offen offset:3072 nt lds
  s_add_u32 s52, s52, 4096
  s_sub_u32 s55, s50, 1
  s_max_i32 s54, s54, s55
  v_mov_b32 v3, s54
  ds_write_b32 v4, v3
  s_add_u32 m0, s51, 4096
  s_waitcnt vmcnt(19)
  buffer_load_dwordx4 v2, s[8:11], s52 offen offset:0 nt lds
  s_waitcnt vmcnt(19)
  buffer_load_dwordx4 v2, s[8:11], s52 offen offset:1024 nt lds
  s_waitcnt vmcnt(19)
  buffer_load_dwordx4 v2, s[8:11], s52 offen offset:2048 nt lds
  s_waitcnt vmcnt(19)
  buffer_load_dwordx4 v2, s[8:11], s52 offen offset:3072 nt lds
  s_add_u32 s52, s52, 4096
  s_add_u32 m0, s51, 8192
  s_waitcnt vmcnt(19)
  buffer_load_dwordx4 v2, s[8:11], s52 offen offset:0 nt lds
  s_waitcnt vmcnt(19)
  buffer_load_dwordx4 v2, s[8:11], s52 offen offset:1024 nt lds
  s_waitcnt vmcnt(19)
  buffer_load_dwordx4 v2, s[8:11], s52 offen offset:2048 nt lds
  s_add_u32 s55, s50, 1
  s_and_b32 s55, s55, 7
  s_lshl_b32 s55, s55, 2
  s_add_u32 s55, s55, 131104
  v_mov_b32 v5, s55
  ds_read_b32 v6, v5
  ds_read_b32 v7, v4 offset:4
  s_waitcnt vmcnt(19)
  buffer_load_dwordx4 v2, s[8:11], s52 offen offset:3072 nt lds
  s_add_u32 s52, s52, 4096
  s_add_u32 m0, s51, 12288
  s_waitcnt vmcnt(19)
  buffer_load_dwordx4 v2, s[8:11], s52 offen offset:0 nt lds
  s_waitcnt vmcnt(19)
  buffer_load_dwordx4 v2, s[8:11], s52 offen offset:1024 nt lds
  s_waitcnt vmcnt(19)
  buffer_load_dwordx4 v2, s[8:11], s52 offen offset:2048 nt lds
  s_waitcnt vmcnt(19)
  buffer_load_dwordx4 v2, s[8:11], s52 offen offset:3072 nt lds
  s_add_u32 s52, s52, 4096
  s_branch L_ld_adv
L_ld_sel:
  s_cmp_ge_u32 s50, 250
  s_cbranch_scc1 L_ld_wB
  s_cmp_eq_u32 s57, 2
  s_cbranch_scc1 L_ld_w2
  s_cmp_eq_u32 s57, 3
  s_cbranch_scc1 L_ld_w3
  s_add_u32 m0, s51, 0
  s_waitcnt vmcnt(18)
  buffer_load_dwordx4 v2, s[8:11], s52 offen offset:0 nt lds
  s_waitcnt vmcnt(18)
  buffer_load_dwordx4 v2, s[8:11], s52 offen offset:1024 nt lds
  s_waitcnt vmcnt(18)
  buffer_load_dwordx4 v2, s[8:11], s52 offen offset:2048 nt lds
  s_sub_u32 s55, s50, 1
  s_max_i32 s54, s54, s55
  v_mov_b32 v3, s54
  ds_write_b32 v4, v3
  s_waitcnt vmcnt(18)
  buffer_load_dwordx4 v2, s[8:11], s52 offen offset:3072 nt lds
  s_add_u32 s52, s52, 4096
  s_add_u32 m0, s51, 4096
  s_waitcnt vmcnt(18)
  buffer_load_dwordx4 v2, s[8:11], s52 offen offset:0 nt lds
  s_waitcnt vmcnt(18)
  buffer_load_dwordx4 v2, s[8:11], s52 offen offset:1024 nt lds
  s_waitcnt vmcnt(18)
  buffer_load_dwordx4 v2, s[8:11], s52 offen offset:2048 nt lds
  s_waitcnt vmcnt(18)
  buffer_load_dwordx4 v2, s[8:11], s52 offen offset:3072 nt lds
  s_add_u32 s52, s52, 4096
  s_add_u32 m0, s51, 8192
  s_waitcnt vmcnt(18)
  buffer_load_dwordx4 v2, s[8:11], s52 offen offset:0 nt lds
  s_waitcnt vmcnt(18)
  buffer_load_dwordx4 v2, s[8:11], s52 offen offset:1024 nt lds
  s_waitcnt vmcnt(18)
  buffer_load_dwordx4 v2, s[8:11], s52 offen offset:2048 nt lds
  s_add_u32 s55, s50, 1
  s_and_b32 s55, s55, 7
  s_lshl_b32 s55, s55, 2
  s_add_u32 s55, s55, 131104
  v_mov_b32 v5, s55
  ds_read_b32 v6, v5
  ds_read_b32 v7, v4 offset:4
  s_waitcnt vmcnt(18)
  buffer_load_dwordx4 v2, s[8:11], s52 offen offset:3072 nt lds
  s_add_u32 s52, s52, 4096
  s_add_u32 m0, s51, 12288
  s_waitcnt vmcnt(18)
  buffer_load_dwordx4 v2, s[8:11], s52 offen offset:0 nt lds
  s_waitcnt vmcnt(18)
  buffer_load_dwordx4 v2, s[8:11], s52 offen offset:1024 nt lds
  s_waitcnt vmcnt(18)
  buffer_load_dwordx4 v2, s[8:11], s52 offen offset:2048 nt lds
  s_waitcnt vmcnt(18)
  buffer_load_dwordx4 v2, s[8:11], s52 offen offset:3072 nt lds
  s_add_u32 s52, s52, 4096
  s_branch L_ld_adv
L_ld_w2:
  s_add_u32 m0, s51, 0
  s_waitcnt vmcnt(22)
  buffer_load_dwordx4 v2, s[8:11], s52 offen offset:0 nt lds
  s_waitcnt vmcnt(22)
  buffer_load_dwordx4 v2, s[8:11], s52 offen offset:1024 nt lds
  s_waitcnt vmcnt(22)
  buffer_load_dwordx4 v2, s[8:11], s52 offen offset:2048 nt lds
  s_waitcnt vmcnt(22)
  buffer_load_dwordx4 v2, s[8:11], s52 offen offset:3072 nt lds
  s_add_u32 s52, s52, 4096
  s_add_u32 m0, s51, 4096
  s_waitcnt vmcnt(22)
  buffer_load_dwordx4 v2, s[8:11], s52 offen offset:0 nt lds
  s_waitcnt vmcnt(22)
  buffer_load_dwordx4 v2, s[8:11], s52 offen offset:1024 nt lds
  s_waitcnt vmcnt(22)
  buffer_load_dwordx4 v2, s[8:11], s52 offen offset:2048 nt lds
  s_sub_u32 s55, s50, 1
  s_max_i32 s54, s54, s55
  v_mov_b32 v3, s54
  ds_write_b32 v4, v3
  s_waitcnt vmcnt(22)
  buffer_load_dwordx4 v2, s[8:11], s52 offen offset:3072 nt lds
  s_add_u32 s52, s52, 4096
  s_add_u32 m0, s51, 8192
  s_waitcnt vmcnt(22)
  buffer_load_dwordx4 v2, s[8:11], s52 offen offset:0 nt lds
  s_waitcnt vmcnt(22)
  buffer_load_dwordx4 v2, s[8:11], s52 offen offset:1024 nt lds
  s_waitcnt vmcnt(22)
  buffer_load_dwordx4 v2, s[8:11], s52 offen offset:2048 nt lds
  s_add_u32 s55, s50, 1
  s_and_b32 s55, s55, 7
  s_lshl_b32 s55, s55, 2
  s_add_u32 s55, s55, 131104
  v_mov_b32 v5, s55
  ds_read_b32 v6, v5
  ds_read_b32 v7, v4 offset:4
  s_waitcnt vmcnt(22)
  buffer_load_dwordx4 v2, s[8:11], s52 offen offset:3072 nt lds
  s_add_u32 s52, s52, 4096
  s_add_u32 m0, s51, 12288
  s_waitcnt vmcnt(22)
  buffer_load_dwordx4 v2, s[8:11], s52 offen offset:0 nt lds
  s_waitcnt vmcnt(22)
  buffer_load_dwordx4 v2, s[8:11], s52 offen offset:1024 nt lds
  s_waitcnt vmcnt(22)
  buffer_load_dwordx4 v2, s[8:11], s52 offen offset:2048 nt lds
  s_waitcnt vmcnt(22)
  buffer_load_dwordx4 v2, s[8:11], s52 offen offset:3072 nt lds
  s_add_u32 s52, s52, 4096
  s_branch L_ld_adv
L_ld_w3:
  s_add_u32 m0, s51, 0
  s_waitcnt vmcnt(25)
  buffer_load_dwordx4 v2, s[8:11], s52 offen offset:0 nt lds
  s_waitcnt vmcnt(25)
  buffer_load_dwordx4 v2, s[8:11], s52 offen offset:1024 nt lds
  s_waitcnt vmcnt(25)
  buffer_load_dwordx4 v2, s[8:11], s52 offen offset:2048 nt lds
  s_waitcnt vmcnt(25)
  buffer_load_dwordx4 v2, s[8:11], s52 offen offset:3072 nt lds
  s_add_u32 s52, s52, 4096
  s_add_u32 m0, s51, 4096
  s_waitcnt vmcnt(25)
  buffer_load_dwordx4 v2, s[8:11], s52 offen offset:0 nt lds
  s_waitcnt vmcnt(25)
  buffer_load_dwordx4 v2, s[8:11], s52 offen offset:1024 nt lds
  s_waitcnt vmcnt(25)
  buffer_load_dwordx4 v2, s[8:11], s52 offen offset:2048 nt lds
  s_waitcnt vmcnt(25)
  buffer_load_dwordx4 v2, s[8:11], s52 offen offset:3072 nt lds
  s_add_u32 s52, s52, 4096
  s_add_u32 m0, s51, 8192
  s_waitcnt vmcnt(25)
  buffer_load_dwordx4 v2, s[8:11], s52 offen offset:0 nt lds
  s_waitcnt vmcnt(25)
  buffer_load_dwordx4 v2, s[8:11], s52 offen offset:1024 nt lds
  s_sub_u32 s55, s50, 1
  s_max_i32 s54, s54, s55
  v_mov_b32 v3, s54
  ds_write_b32 v4, v3
  s_waitcnt vmcnt(25)
  buffer_load_dwordx4 v2, s[8:11], s52 offen offset:2048 nt lds
  s_add_u32 s55, s50, 1
  s_and_b32 s55, s55, 7
  s_lshl_b32 s55, s55, 2
  s_add_u32 s55, s55, 131104
  v_mov_b32 v5, s55
  ds_read_b32 v6, v5
  ds_read_b32 v7, v4 offset:4
  s_waitcnt vmcnt(25)
  buffer_load_dwordx4 v2, s[8:11], s52 offen offset:3072 nt lds
  s_add_u32 s52, s52, 4096
  s_add_u32 m0, s51, 12288
  s_waitcnt vmcnt(25)
  buffer_load_dwordx4 v2, s[8:11], s52 offen offset:0 nt lds
  s_waitcnt vmcnt(25)
  buffer_load_dwordx4 v2, s[8:11], s52 offen offset:1024 nt lds
  s_waitcnt vmcnt(25)
  buffer_load_dwordx4 v2, s[8:11], s52 offen offset:2048 nt lds
  s_waitcnt vmcnt(25)
  buffer_load_dwordx4 v2, s[8:11], s52 offen offset:3072 nt lds
  s_add_u32 s52, s52, 4096
  s_branch L_ld_adv
L_ld_slow:
  s_waitcnt vmcnt(0)
  s_max_u32 s54, s54, s50
  v_mov_b32 v3, s54
  ds_write_b32 v4, v3
L_ld_slow2:
  s_sub_u32 s98, s98, 1
  s_cbranch_scc1 L_end
  s_sleep 1
  ds_read_b32 v6, v5
  s_waitcnt lgkmcnt(0)
  v_readfirstlane_b32 s56, v6
  s_lshr_b32 s55, s50, 3
  s_cmp_ge_u32 s56, s55
  s_cbranch_scc0 L_ld_slow2
  s_branch L_ld_go
L_ld_wB:
  s_add_u32 m0, s51, 0
  s_waitcnt vmcnt(39)
  buffer_load_dwordx4 v2, s[8:11], s52 offen offset:0 nt lds
  s_waitcnt vmcnt(39)
  buffer_load_dwordx4 v2, s[8:11], s52 offen offset:1024 nt lds
  s_waitcnt vmcnt(39)
  buffer_load_dwordx4 v2, s[8:11], s52 offen offset:2048 nt lds
  s_waitcnt vmcnt(39)
  buffer_load_dwordx4 v2, s[8:11], s52 offen offset:3072 nt lds
  s_add_u32 s52, s52, 4096
  s_add_u32 m0, s51, 4096
  s_waitcnt vmcnt(39)
  buffer_load_dwordx4 v2, s[8:11], s52 offen offset:0 nt lds
  s_waitcnt vmcnt(39)
  buffer_load_dwordx4 v2, s[8:11], s52 offen offset:1024 nt lds
  s_waitcnt vmcnt(39)
  buffer_load_dwordx4 v2, s[8:11], s52 offen offset:2048 nt lds
  s_waitcnt vmcnt(39)
  buffer_load_dwordx4 v2, s[8:11], s52 offen offset:3072 nt lds
  s_add_u32 s52, s52, 4096
  s_sub_u32 s55, s50, 2
  s_max_i32 s54, s54, s55
  v_mov_b32 v3, s54
  ds_write_b32 v4, v3
  s_add_u32 m0, s51, 8192
  s_waitcnt vmcnt(39)
  buffer_load_dwordx4 v2, s[8:11], s52 offen offset:0 nt lds
  s_waitcnt vmcnt(39)
  buffer_load_dwordx4 v2, s[8:11], s52 offen offset:1024 nt lds
  s_waitcnt vmcnt(39)
  buffer_load_dwordx4 v2, s[8:11], s52 offen offset:2048 nt lds
  s_add_u32 s55, s50, 1
  s_and_b32 s55, s55, 7
  s_lshl_b32 s55, s55, 2
  s_add_u32 s55, s55, 131104
  v_mov_b32 v5, s55
  ds_read_b32 v6, v5
  ds_read_b32 v7, v4 offset:4
  s_waitcnt vmcnt(39)
  buffer_load_dwordx4 v2, s[8:11], s52 offen offset:3072 nt lds
  s_add_u32 s52, s52, 4096
  s_add_u32 m0, s51, 12288
  s_waitcnt vmcnt(39)
  buffer_load_dwordx4 v2, s[8:11], s52 offen offset:0 nt lds
  s_waitcnt vmcnt(39)
  buffer_load_dwordx4 v2, s[8:11], s52 offen offset:1024 nt lds
  s_waitcnt vmcnt(39)
  buffer_load_dwordx4 v2, s[8:11], s52 offen offset:2048 nt lds
  s_waitcnt vmcnt(39)
  buffer_load_dwordx4 v2, s[8:11], s52 offen offset:3072 nt lds
  s_add_u32 s52, s52, 4096
  s_branch L_ld_adv
L_ld_sw:
  s_mov_b32 s8, s12
  s_mov_b32 s9, s13
  s_mov_b32 s52, s53
  s_branch L_ld_loop
L_ld_adv:
  s_add_u32 s50, s50, 1
  s_add_u32 s51, s51, 16384
  s_and_b32 s51, s51, 131071
  s_add_u32 s52, s52, 114688
  s_and_b32 s52, s52, 0xffffff
  s_and_b32 s55, s50, 127
  s_cbranch_scc1 L_ld_loop
  s_cmp_lt_u32 s50, 256
  s_cbranch_scc1 L_ld_sw
  s_mov_b32 s12, s24
  s_mov_b32 s13, s25
  s_mov_b32 s14, 4194304
  s_mov_b32 s15, 0x20000
  v_and_b32 v8, 7, v0
  v_lshlrev_b32 v8, 12, v8
  v_lshrrev_b32 v9, 3, v0
  v_lshl_add_u32 v8, v9, 4, v8
  s_lshl_b32 s52, s4, 17
  s_lshl_b32 s55, s5, 7
  s_add_u32 s52, s52, s55
L_ld_wo:
  s_waitcnt lgkmcnt(0)
  v_readfirstlane_b32 s56, v6
  s_cmp_ge_u32 s56, 32
  s_cbranch_scc1 L_ld_wo2
  s_sub_u32 s98, s98, 1
  s_cbranch_scc1 L_end
  ds_read_b32 v6, v5
  s_branch L_ld_wo
L_ld_wo2:
  s_mov_b32 m0, 0
  s_waitcnt vmcnt(39)
  buffer_load_dwordx4 v8, s[12:15], s52 offen offset:0 nt lds
  s_waitcnt vmcnt(39)
  buffer_load_dwordx4 v8, s[12:15], s52 offen offset:1024 nt lds
  s_waitcnt vmcnt(39)
  buffer_load_dwordx4 v8, s[12:15], s52 offen offset:2048 nt lds
  s_waitcnt vmcnt(39)
  buffer_load_dwordx4 v8, s[12:15], s52 offen offset:3072 nt lds
  s_add_u32 s52, s52, 32768
  s_mov_b32 m0, 4096
  s_waitcnt vmcnt(39)
  buffer_load_dwordx4 v8, s[12:15], s52 offen offset:0 nt lds
  s_waitcnt vmcnt(39)
  buffer_load_dwordx4 v8, s[12:15], s52 offen offset:1024 nt lds
  s_waitcnt vmcnt(39)
  buffer_load_dwordx4 v8, s[12:15], s52 offen offset:2048 nt lds
  s_waitcnt vmcnt(39)
  buffer_load_dwordx4 v8, s[12:15], s52 offen offset:3072 nt lds
  s_add_u32 s52, s52, 32768
  s_max_u32 s54, s54, 254
  v_mov_b32 v3, s54
  ds_write_b32 v4, v3
  s_mov_b32 m0, 8192
  s_waitcnt vmcnt(39)
  buffer_load_dwordx4 v8, s[12:15], s52 offen offset:0 nt lds
  s_waitcnt vmcnt(39)
  buffer_load_dwordx4 v8, s[12:15], s52 offen offset:1024 nt lds
  s_waitcnt vmcnt(39)
  buffer_load_dwordx4 v8, s[12:15], s52 offen offset:2048 nt lds
  s_waitcnt vmcnt(39)
  buffer_load_dwordx4 v8, s[12:15], s52 offen offset:3072 nt lds
  s_add_u32 s52, s52, 32768
  s_mov_b32 m0, 12288
  s_waitcnt vmcnt(39)
  buffer_load_dwordx4 v8, s[12:15], s52 offen offset:0 nt lds
  s_waitcnt vmcnt(39)
  buffer_load_dwordx4 v8, s[12:15], s52 offen offset:1024 nt lds
  s_waitcnt vmcnt(39)
  buffer_load_dwordx4 v8, s[12:15], s52 offen offset:2048 nt lds
  s_waitcnt vmcnt(39)
  buffer_load_dwordx4 v8, s[12:15], s52 offen offset:3072 nt lds
  s_add_u32 s52, s52, 32768
  s_waitcnt vmcnt(48)
  s_max_u32 s54, s54, 254
  v_mov_b32 v3, s54
  ds_write_b32 v4, v3
  s_waitcnt vmcnt(32)
  s_max_u32 s54, s54, 255
  v_mov_b32 v3, s54
  ds_write_b32 v4, v3
  s_waitcnt vmcnt(16)
  s_max_u32 s54, s54, 256
  v_mov_b32 v3, s54
  ds_write_b32 v4, v3
  s_waitcnt lgkmcnt(0)
  s_barrier
  s_waitcnt vmcnt(0)
  s_mov_b32 s54, 257
  v_mov_b32 v3, s54
  ds_write_b32 v4, v3
  s_waitcnt lgkmcnt(0)
  s_endpgm
L_notloader:
  s_cmp_eq_u32 s3, 5
  s_cbranch_scc1 L_helper
  s_mov_b32 s8, s16
  s_mov_b32 s9, s17
  s_mov_b32 s10, 1024
  s_mov_b32 s11, 0x20000
  s_mov_b32 s12, s22
  s_mov_b32 s13, s23
  s_mov_b32 s14, 4194304
  s_mov_b32 s15, 0x20000
  buffer_load_dwordx4 v[28:31], v2, s[8:11], 0 offen nt
  s_barrier
  s_sub_u32 s6, s3, 1
  v_lshrrev_b32 v4, 4, v0
  v_and_b32 v5, 15, v0
  v_lshlrev_b32 v6, 13, v4
  v_lshl_add_u32 v6, v5, 4, v6
  s_lshl_b32 s56, s6, 20
  s_lshl_b32 s57, s4, 8
  s_add_u32 s56, s56, s57
  buffer_load_dwordx4 v[32:35], v6, s[12:15], s56 offen nt
  s_add_u32 s56, s56, 32768
  buffer_load_dwordx4 v[36:39], v6, s[12:15], s56 offen nt
  s_add_u32 s56, s56, 32768
  buffer_load_dwordx4 v[40:43], v6, s[12:15], s56 offen nt
  s_add_u32 s56, s56, 32768
  buffer_load_dwordx4 v[44:47], v6, s[12:15], s56 offen nt
  s_add_u32 s56, s56, 32768
  buffer_load_dwordx4 v[48:51], v6, s[12:15], s56 offen nt
  s_add_u32 s56, s56, 32768
  buffer_load_dwordx4 v[52:55], v6, s[12:15], s56 offen nt
  s_add_u32 s56, s56, 32768
  buffer_load_dwordx4 v[56:59], v6, s[12:15], s56 offen nt
  s_add_u32 s56, s56, 32768
  buffer_load_dwordx4 v[60:63], v6, s[12:15], s56 offen nt
  s_add_u32 s56, s56, 32768
  buffer_load_dwordx4 v[64:67], v6, s[12:15], s56 offen nt
  s_add_u32 s56, s56, 32768
  buffer_load_dwordx4 v[68:71], v6, s[12:15], s56 offen nt
  s_add_u32 s56, s56, 32768
  buffer_load_dwordx4 v[72:75], v6, s[12:15], s56 offen nt
  s_add_u32 s56, s56, 32768
  buffer_load_dwordx4 v[76:79], v6, s[12:15], s56 offen nt
  s_add_u32 s56, s56, 32768
  buffer_load_dwordx4 v[80:83], v6, s[12:15], s56 offen nt
  s_add_u32 s56, s56, 32768
  buffer_load_dwordx4 v[84:87], v6, s[12:15], s56 offen nt
  s_add_u32 s56, s56, 32768
  buffer_load_dwordx4 v[88:91], v6, s[12:15], s56 offen nt
  s_add_u32 s56, s56, 32768
  buffer_load_dwordx4 v[92:95], v6, s[12:15], s56 offen nt
  s_add_u32 s56, s56, 32768
  buffer_load_dwordx4 v[96:99], v6, s[12:15], s56 offen nt
  s_add_u32 s56, s56, 32768
  buffer_load_dwordx4 v[100:103], v6, s[12:15], s56 offen nt
  s_add_u32 s56, s56, 32768
  buffer_load_dwordx4 v[104:107], v6, s[12:15], s56 offen nt
  s_add_u32 s56, s56, 32768
  buffer_load_dwordx4 v[108:111], v6, s[12:15], s56 offen nt
  s_add_u32 s56, s56, 32768
  buffer_load_dwordx4 v[112:115], v6, s[12:15], s56 offen nt
  s_add_u32 s56, s56, 32768
  buffer_load_dwordx4 v[116:119], v6, s[12:15], s56 offen nt
  s_add_u32 s56, s56, 32768
  buffer_load_dwordx4 v[120:123], v6, s[12:15], s56 offen nt
  s_add_u32 s56, s56, 32768
  buffer_load_dwordx4 v[124:127], v6, s[12:15], s56 offen nt
  s_add_u32 s56, s56, 32768
  buffer_load_dwordx4 v[128:131], v6, s[12:15], s56 offen nt
  s_add_u32 s56, s56, 32768
  buffer_load_dwordx4 v[132:135], v6, s[12:15], s56 offen nt
  s_add_u32 s56, s56, 32768
  buffer_load_dwordx4 v[136:139], v6, s[12:15], s56 offen nt
  s_add_u32 s56, s56, 32768
  buffer_load_dwordx4 v[140:143], v6, s[12:15], s56 offen nt
  s_add_u32 s56, s56, 32768
  buffer_load_dwordx4 v[144:147], v6, s[12:15], s56 offen nt
  s_add_u32 s56, s56, 32768
  buffer_load_dwordx4 v[148:151], v6, s[12:15], s56 offen nt
  s_add_u32 s56, s56, 32768
  buffer_load_dwordx4 v[152:155], v6, s[12:15], s56 offen nt
  s_add_u32 s56, s56, 32768
  buffer_load_dwordx4 v[156:159], v6, s[12:15], s56 offen nt
  s_add_u32 s56, s56, 32768
  s_mov_b32 s44, s40
  s_mov_b32 s45, s41
  s_mov_b32 s46, 983040
  s_mov_b32 s47, 0x20000
  s_mov_b32 s48, s24
  s_mov_b32 s49, s25
  s_mov_b32 s50, 4194304
  s_mov_b32 s51, 0x20000
  s_mov_b32 s52, s36
  s_mov_b32 s53, s37
  s_mov_b32 s54, 1024
  s_mov_b32 s55, 0x20000
  s_lshl_b32 s74, s6, 11
  s_add_u32 s74, s74, 131584
  s_waitcnt vmcnt(32)
  v_lshlrev_b32 v8, 16, v28
  v_and_b32 v9, 0xffff0000, v28
  v_lshlrev_b32 v10, 16, v29
  v_and_b32 v11, 0xffff0000, v29
  v_lshlrev_b32 v12, 16, v30
  v_and_b32 v13, 0xffff0000, v30
  v_lshlrev_b32 v14, 16, v31
  v_and_b32 v15, 0xffff0000, v31
  v_add_f32 v16, v8, v9
  v_add_f32 v17, v10, v11
  v_add_f32 v18, v12, v13
  v_add_f32 v19, v14, v15
  v_add_f32 v16, v16, v17
  v_add_f32 v18, v18, v19
  v_add_f32 v16, v16, v18
  s_nop 1
  v_add_f32_dpp v16, v16, v16 row_ror:1 row_mask:0xf bank_mask:0xf
  s_nop 1
  v_add_f32_dpp v16, v16, v16 row_ror:2 row_mask:0xf bank_mask:0xf
  s_nop 1
  v_add_f32_dpp v16, v16, v16 row_ror:4 row_mask:0xf bank_mask:0xf
  s_nop 1
  v_add_f32_dpp v16, v16, v16 row_ror:8 row_mask:0xf bank_mask:0xf
  s_nop 0
  v_readlane_b32 s60, v16, 0
  v_readlane_b32 s61, v16, 16
  v_readlane_b32 s62, v16, 32
  v_readlane_b32 s63, v16, 48
  s_nop 1
  v_mov_b32 v16, s60
  v_mov_b32 v17, s62
  v_add_f32 v16, s61, v16
  v_add_f32 v17, s63, v17
  v_add_f32 v16, v16, v17
  v_mul_f32 v16, 0x3b000000, v16
  v_mov_b32 v18, 0
  v_sub_f32 v19, v8, v16
  v_fmac_f32 v18, v19, v19
  v_sub_f32 v19, v9, v16
  v_fmac_f32 v18, v19, v19
  v_sub_f32 v19, v10, v16
  v_fmac_f32 v18, v19, v19
  v_sub_f32 v19, v11, v16
  v_fmac_f32 v18, v19, v19
  v_sub_f32 v19, v12, v16
  v_fmac_f32 v18, v19, v19
  v_sub_f32 v19, v13, v16
  v_fmac_f32 v18, v19, v19
  v_sub_f32 v19, v14, v16
  v_fmac_f32 v18, v19, v19
  v_sub_f32 v19, v15, v16
  v_fmac_f32 v18, v19, v19
  s_nop 1
  v_add_f32_dpp v18, v18, v18 row_ror:1 row_mask:0xf bank_mask:0xf
  s_nop 1
  v_add_f32_dpp v18, v18, v18 row_ror:2 row_mask:0xf bank_mask:0xf
  s_nop 1
  v_add_f32_dpp v18, v18, v18 row_ror:4 row_mask:0xf bank_mask:0xf
  s_nop 1
  v_add_f32_dpp v18, v18, v18 row_ror:8 row_mask:0xf bank_mask:0xf
  s_nop 0
  v_readlane_b32 s60, v18, 0
  v_readlane_b32 s61, v18, 16
  v_readlane_b32 s62, v18, 32
  v_readlane_b32 s63, v18, 48
  s_nop 1
  v_mov_b32 v18, s60
  v_mov_b32 v17, s62
  v_add_f32 v18, s61, v18
  v_add_f32 v17, s63, v17
  v_add_f32 v18, v18, v17
  v_mul_f32 v18, 0x3b000000, v18
  v_cvt_pk_bf16_f32 v16, 0, v16
  v_cvt_pk_bf16_f32 v18, 0, v18
  v_add_f32 v18, 0x3727c5ac, v18
  v_cvt_pk_bf16_f32 v18, 0, v18
  v_sqrt_f32 v18, v18
  s_nop 0
  v_cvt_pk_bf16_f32 v18, 0, v18
  v_rcp_f32 v19, v18
  v_sub_f32 v8, v8, v16
  v_sub_f32 v9, v9, v16
  v_sub_f32 v10, v10, v16
  v_sub_f32 v11, v11, v16
  v_sub_f32 v12, v12, v16
  v_sub_f32 v13, v13, v16
  v_sub_f32 v14, v14, v16
  v_sub_f32 v15, v15, v16
  v_cvt_pk_bf16_f32 v8, 0, v8
  v_cvt_pk_bf16_f32 v9, 0, v9
  v_cvt_pk_bf16_f32 v10, 0, v10
  v_cvt_pk_bf16_f32 v11, 0, v11
  v_cvt_pk_bf16_f32 v12, 0, v12
  v_cvt_pk_bf16_f32 v13, 0, v13
  v_cvt_pk_bf16_f32 v14, 0, v14
  v_cvt_pk_bf16_f32 v15, 0, v15
  v_mul_f32 v20, v8, v19
  v_mul_f32 v21, v9, v19
  v_mul_f32 v22, v10, v19
  v_mul_f32 v23, v11, v19
  v_mul_f32 v24, v12, v19
  v_mul_f32 v25, v13, v19
  v_mul_f32 v26, v14, v19
  v_mul_f32 v27, v15, v19
  v_fma_f32 v8, -v20, v18, v8
  v_fma_f32 v9, -v21, v18, v9
  v_fma_f32 v10, -v22, v18, v10
  v_fma_f32 v11, -v23, v18, v11
  v_fma_f32 v12, -v24, v18, v12
  v_fma_f32 v13, -v25, v18, v13
  v_fma_f32 v14, -v26, v18, v14
  v_fma_f32 v15, -v27, v18, v15
  v_fma_f32 v20, v8, v19, v20
  v_fma_f32 v21, v9, v19, v21
  v_fma_f32 v22, v10, v19, v22
  v_fma_f32 v23, v11, v19, v23
  v_fma_f32 v24, v12, v19, v24
  v_fma_f32 v25, v13, v19, v25
  v_fma_f32 v26, v14, v19, v26
  v_fma_f32 v27, v15, v19, v27
  v_cvt_pk_bf16_f32 v20, 0, v20
  v_cvt_pk_bf16_f32 v21, 0, v21
  v_cvt_pk_bf16_f32 v22, 0, v22
  v_cvt_pk_bf16_f32 v23, 0, v23
  v_cvt_pk_bf16_f32 v24, 0, v24
  v_cvt_pk_bf16_f32 v25, 0, v25
  v_cvt_pk_bf16_f32 v26, 0, v26
  v_cvt_pk_bf16_f32 v27, 0, v27
  v_lshlrev_b32 v16, 5, v0
  v_add_u32 v16, s74, v16
  ds_write_b128 v16, v[20:23]
  ds_write_b128 v16, v[24:27] offset:16
  s_lshl_b32 s57, s6, 9
  s_add_u32 s57, s57, s74
  v_lshlrev_b32 v3, 2, v4
  v_add_u32 v3, s57, v3
  v_mov_b32 v8, 0
  v_mov_b32 v9, 0
  v_mov_b32 v10, 0
  v_mov_b32 v11, 0
  v_mov_b32 v12, 0
  v_mov_b32 v13, 0
  v_mov_b32 v14, 0
  v_mov_b32 v15, 0
  s_waitcnt lgkmcnt(0)
  ds_read_b32 v16, v3 offset:0
  ds_read_b32 v17, v3 offset:16
  ds_read_b32 v18, v3 offset:32
  ds_read_b32 v19, v3 offset:48
  ds_read_b32 v20, v3 offset:64
  ds_read_b32 v21, v3 offset:80
  ds_read_b32 v22, v3 offset:96
  ds_read_b32 v23, v3 offset:112
  s_waitcnt vmcnt(31) lgkmcnt(7)
  v_lshrrev_b32 v24, 16, v16
  v_dot2c_f32_bf16 v8, v24, v32
  v_dot2c_f32_bf16 v9, v16, v32
  v_dot2c_f32_bf16 v10, v24, v33
  v_dot2c_f32_bf16 v11, v16, v33
  v_dot2c_f32_bf16 v12, v24, v34
  v_dot2c_f32_bf16 v13, v16, v34
  v_dot2c_f32_bf16 v14, v24, v35
  v_dot2c_f32_bf16 v15, v16, v35
  s_waitcnt vmcnt(30) lgkmcnt(6)
  v_lshrrev_b32 v24, 16, v17
  v_dot2c_f32_bf16 v8, v24, v36
  v_dot2c_f32_bf16 v9, v17, v36
  v_dot2c_f32_bf16 v10, v24, v37
  v_dot2c_f32_bf16 v11, v17, v37
  v_dot2c_f32_bf16 v12, v24, v38
  v_dot2c_f32_bf16 v13, v17, v38
  v_dot2c_f32_bf16 v14, v24, v39
  v_dot2c_f32_bf16 v15, v17, v39
  s_waitcnt vmcnt(29) lgkmcnt(5)
  v_lshrrev_b32 v24, 16, v18
  v_dot2c_f32_bf16 v8, v24, v40
  v_dot2c_f32_bf16 v9, v18, v40
  v_dot2c_f32_bf16 v10, v24, v41
  v_dot2c_f32_bf16 v11, v18, v41
  v_dot2c_f32_bf16 v12, v24, v42
  v_dot2c_f32_bf16 v13, v18, v42
  v_dot2c_f32_bf16 v14, v24, v43
  v_dot2c_f32_bf16 v15, v18, v43
  s_waitcnt vmcnt(28) lgkmcnt(4)
  v_lshrrev_b32 v24, 16, v19
  v_dot2c_f32_bf16 v8, v24, v44
  v_dot2c_f32_bf16 v9, v19, v44
  v_dot2c_f32_bf16 v10, v24, v45
  v_dot2c_f32_bf16 v11, v19, v45
  v_dot2c_f32_bf16 v12, v24, v46
  v_dot2c_f32_bf16 v13, v19, v46
  v_dot2c_f32_bf16 v14, v24, v47
  v_dot2c_f32_bf16 v15, v19, v47
  s_waitcnt vmcnt(27) lgkmcnt(3)
  v_lshrrev_b32 v24, 16, v20
  v_dot2c_f32_bf16 v8, v24, v48
  v_dot2c_f32_bf16 v9, v20, v48
  v_dot2c_f32_bf16 v10, v24, v49
  v_dot2c_f32_bf16 v11, v20, v49
  v_dot2c_f32_bf16 v12, v24, v50
  v_dot2c_f32_bf16 v13, v20, v50
  v_dot2c_f32_bf16 v14, v24, v51
  v_dot2c_f32_bf16 v15, v20, v51
  s_waitcnt vmcnt(26) lgkmcnt(2)
  v_lshrrev_b32 v24, 16, v21
  v_dot2c_f32_bf16 v8, v24, v52
  v_dot2c_f32_bf16 v9, v21, v52
  v_dot2c_f32_bf16 v10, v24, v53
  v_dot2c_f32_bf16 v11, v21, v53
  v_dot2c_f32_bf16 v12, v24, v54
  v_dot2c_f32_bf16 v13, v21, v54
  v_dot2c_f32_bf16 v14, v24, v55
  v_dot2c_f32_bf16 v15, v21, v55
  s_waitcnt vmcnt(25) lgkmcnt(1)
  v_lshrrev_b32 v24, 16, v22
  v_dot2c_f32_bf16 v8, v24, v56
  v_dot2c_f32_bf16 v9, v22, v56
  v_dot2c_f32_bf16 v10, v24, v57
  v_dot2c_f32_bf16 v11, v22, v57
  v_dot2c_f32_bf16 v12, v24, v58
  v_dot2c_f32_bf16 v13, v22, v58
  v_dot2c_f32_bf16 v14, v24, v59
  v_dot2c_f32_bf16 v15, v22, v59
  s_waitcnt vmcnt(24) lgkmcnt(0)
  v_lshrrev_b32 v24, 16, v23
  v_dot2c_f32_bf16 v8, v24, v60
  v_dot2c_f32_bf16 v9, v23, v60
  v_dot2c_f32_bf16 v10, v24, v61
  v_dot2c_f32_bf16 v11, v23, v61
  v_dot2c_f32_bf16 v12, v24, v62
  v_dot2c_f32_bf16 v13, v23, v62
  v_dot2c_f32_bf16 v14, v24, v63
  v_dot2c_f32_bf16 v15, v23, v63
  ds_read_b32 v16, v3 offset:128
  ds_read_b32 v17, v3 offset:144
  ds_read_b32 v18, v3 offset:160
  ds_read_b32 v19, v3 offset:176
  ds_read_b32 v20, v3 offset:192
  ds_read_b32 v21, v3 offset:208
  ds_read_b32 v22, v3 offset:224
  ds_read_b32 v23, v3 offset:240
  s_waitcnt vmcnt(23) lgkmcnt(7)
  v_lshrrev_b32 v24, 16, v16
  v_dot2c_f32_bf16 v8, v24, v64
  v_dot2c_f32_bf16 v9, v16, v64
  v_dot2c_f32_bf16 v10, v24, v65
  v_dot2c_f32_bf16 v11, v16, v65
  v_dot2c_f32_bf16 v12, v24, v66
  v_dot2c_f32_bf16 v13, v16, v66
  v_dot2c_f32_bf16 v14, v24, v67
  v_dot2c_f32_bf16 v15, v16, v67
  s_waitcnt vmcnt(22) lgkmcnt(6)
  v_lshrrev_b32 v24, 16, v17
  v_dot2c_f32_bf16 v8, v24, v68
  v_dot2c_f32_bf16 v9, v17, v68
  v_dot2c_f32_bf16 v10, v24, v69
  v_dot2c_f32_bf16 v11, v17, v69
  v_dot2c_f32_bf16 v12, v24, v70
  v_dot2c_f32_bf16 v13, v17, v70
  v_dot2c_f32_bf16 v14, v24, v71
  v_dot2c_f32_bf16 v15, v17, v71
  s_waitcnt vmcnt(21) lgkmcnt(5)
  v_lshrrev_b32 v24, 16, v18
  v_dot2c_f32_bf16 v8, v24, v72
  v_dot2c_f32_bf16 v9, v18, v72
  v_dot2c_f32_bf16 v10, v24, v73
  v_dot2c_f32_bf16 v11, v18, v73
  v_dot2c_f32_bf16 v12, v24, v74
  v_dot2c_f32_bf16 v13, v18, v74
  v_dot2c_f32_bf16 v14, v24, v75
  v_dot2c_f32_bf16 v15, v18, v75
  s_waitcnt vmcnt(20) lgkmcnt(4)
  v_lshrrev_b32 v24, 16, v19
  v_dot2c_f32_bf16 v8, v24, v76
  v_dot2c_f32_bf16 v9, v19, v76
  v_dot2c_f32_bf16 v10, v24, v77
  v_dot2c_f32_bf16 v11, v19, v77
  v_dot2c_f32_bf16 v12, v24, v78
  v_dot2c_f32_bf16 v13, v19, v78
  v_dot2c_f32_bf16 v14, v24, v79
  v_dot2c_f32_bf16 v15, v19, v79
  s_waitcnt vmcnt(19) lgkmcnt(3)
  v_lshrrev_b32 v24, 16, v20
  v_dot2c_f32_bf16 v8, v24, v80
  v_dot2c_f32_bf16 v9, v20, v80
  v_dot2c_f32_bf16 v10, v24, v81
  v_dot2c_f32_bf16 v11, v20, v81
  v_dot2c_f32_bf16 v12, v24, v82
  v_dot2c_f32_bf16 v13, v20, v82
  v_dot2c_f32_bf16 v14, v24, v83
  v_dot2c_f32_bf16 v15, v20, v83
  s_waitcnt vmcnt(18) lgkmcnt(2)
  v_lshrrev_b32 v24, 16, v21
  v_dot2c_f32_bf16 v8, v24, v84
  v_dot2c_f32_bf16 v9, v21, v84
  v_dot2c_f32_bf16 v10, v24, v85
  v_dot2c_f32_bf16 v11, v21, v85
  v_dot2c_f32_bf16 v12, v24, v86
  v_dot2c_f32_bf16 v13, v21, v86
  v_dot2c_f32_bf16 v14, v24, v87
  v_dot2c_f32_bf16 v15, v21, v87
  s_waitcnt vmcnt(17) lgkmcnt(1)
  v_lshrrev_b32 v24, 16, v22
  v_dot2c_f32_bf16 v8, v24, v88
  v_dot2c_f32_bf16 v9, v22, v88
  v_dot2c_f32_bf16 v10, v24, v89
  v_dot2c_f32_bf16 v11, v22, v89
  v_dot2c_f32_bf16 v12, v24, v90
  v_dot2c_f32_bf16 v13, v22, v90
  v_dot2c_f32_bf16 v14, v24, v91
  v_dot2c_f32_bf16 v15, v22, v91
  s_waitcnt vmcnt(16) lgkmcnt(0)
  v_lshrrev_b32 v24, 16, v23
  v_dot2c_f32_bf16 v8, v24, v92
  v_dot2c_f32_bf16 v9, v23, v92
  v_dot2c_f32_bf16 v10, v24, v93
  v_dot2c_f32_bf16 v11, v23, v93
  v_dot2c_f32_bf16 v12, v24, v94
  v_dot2c_f32_bf16 v13, v23, v94
  v_dot2c_f32_bf16 v14, v24, v95
  v_dot2c_f32_bf16 v15, v23, v95
  ds_read_b32 v16, v3 offset:256
  ds_read_b32 v17, v3 offset:272
  ds_read_b32 v18, v3 offset:288
  ds_read_b32 v19, v3 offset:304
  ds_read_b32 v20, v3 offset:320
  ds_read_b32 v21, v3 offset:336
  ds_read_b32 v22, v3 offset:352
  ds_read_b32 v23, v3 offset:368
  s_waitcnt vmcnt(15) lgkmcnt(7)
  v_lshrrev_b32 v24, 16, v16
  v_dot2c_f32_bf16 v8, v24, v96
  v_dot2c_f32_bf16 v9, v16, v96
  v_dot2c_f32_bf16 v10, v24, v97
  v_dot2c_f32_bf16 v11, v16, v97
  v_dot2c_f32_bf16 v12, v24, v98
  v_dot2c_f32_bf16 v13, v16, v98
  v_dot2c_f32_bf16 v14, v24, v99
  v_dot2c_f32_bf16 v15, v16, v99
  s_waitcnt vmcnt(14) lgkmcnt(6)
  v_lshrrev_b32 v24, 16, v17
  v_dot2c_f32_bf16 v8, v24, v100
  v_dot2c_f32_bf16 v9, v17, v100
  v_dot2c_f32_bf16 v10, v24, v101
  v_dot2c_f32_bf16 v11, v17, v101
  v_dot2c_f32_bf16 v12, v24, v102
  v_dot2c_f32_bf16 v13, v17, v102
  v_dot2c_f32_bf16 v14, v24, v103
  v_dot2c_f32_bf16 v15, v17, v103
  s_waitcnt vmcnt(13) lgkmcnt(5)
  v_lshrrev_b32 v24, 16, v18
  v_dot2c_f32_bf16 v8, v24, v104
  v_dot2c_f32_bf16 v9, v18, v104
  v_dot2c_f32_bf16 v10, v24, v105
  v_dot2c_f32_bf16 v11, v18, v105
  v_dot2c_f32_bf16 v12, v24, v106
  v_dot2c_f32_bf16 v13, v18, v106
  v_dot2c_f32_bf16 v14, v24, v107
  v_dot2c_f32_bf16 v15, v18, v107
  s_waitcnt vmcnt(12) lgkmcnt(4)
  v_lshrrev_b32 v24, 16, v19
  v_dot2c_f32_bf16 v8, v24, v108
  v_dot2c_f32_bf16 v9, v19, v108
  v_dot2c_f32_bf16 v10, v24, v109
  v_dot2c_f32_bf16 v11, v19, v109
  v_dot2c_f32_bf16 v12, v24, v110
  v_dot2c_f32_bf16 v13, v19, v110
  v_dot2c_f32_bf16 v14, v24, v111
  v_dot2c_f32_bf16 v15, v19, v111
  s_waitcnt vmcnt(11) lgkmcnt(3)
  v_lshrrev_b32 v24, 16, v20
  v_dot2c_f32_bf16 v8, v24, v112
  v_dot2c_f32_bf16 v9, v20, v112
  v_dot2c_f32_bf16 v10, v24, v113
  v_dot2c_f32_bf16 v11, v20, v113
  v_dot2c_f32_bf16 v12, v24, v114
  v_dot2c_f32_bf16 v13, v20, v114
  v_dot2c_f32_bf16 v14, v24, v115
  v_dot2c_f32_bf16 v15, v20, v115
  s_waitcnt vmcnt(10) lgkmcnt(2)
  v_lshrrev_b32 v24, 16, v21
  v_dot2c_f32_bf16 v8, v24, v116
  v_dot2c_f32_bf16 v9, v21, v116
  v_dot2c_f32_bf16 v10, v24, v117
  v_dot2c_f32_bf16 v11, v21, v117
  v_dot2c_f32_bf16 v12, v24, v118
  v_dot2c_f32_bf16 v13, v21, v118
  v_dot2c_f32_bf16 v14, v24, v119
  v_dot2c_f32_bf16 v15, v21, v119
  s_waitcnt vmcnt(9) lgkmcnt(1)
  v_lshrrev_b32 v24, 16, v22
  v_dot2c_f32_bf16 v8, v24, v120
  v_dot2c_f32_bf16 v9, v22, v120
  v_dot2c_f32_bf16 v10, v24, v121
  v_dot2c_f32_bf16 v11, v22, v121
  v_dot2c_f32_bf16 v12, v24, v122
  v_dot2c_f32_bf16 v13, v22, v122
  v_dot2c_f32_bf16 v14, v24, v123
  v_dot2c_f32_bf16 v15, v22, v123
  s_waitcnt vmcnt(8) lgkmcnt(0)
  v_lshrrev_b32 v24, 16, v23
  v_dot2c_f32_bf16 v8, v24, v124
  v_dot2c_f32_bf16 v9, v23, v124
  v_dot2c_f32_bf16 v10, v24, v125
  v_dot2c_f32_bf16 v11, v23, v125
  v_dot2c_f32_bf16 v12, v24, v126
  v_dot2c_f32_bf16 v13, v23, v126
  v_dot2c_f32_bf16 v14, v24, v127
  v_dot2c_f32_bf16 v15, v23, v127
  ds_read_b32 v16, v3 offset:384
  ds_read_b32 v17, v3 offset:400
  ds_read_b32 v18, v3 offset:416
  ds_read_b32 v19, v3 offset:432
  ds_read_b32 v20, v3 offset:448
  ds_read_b32 v21, v3 offset:464
  ds_read_b32 v22, v3 offset:480
  ds_read_b32 v23, v3 offset:496
  s_waitcnt vmcnt(7) lgkmcnt(7)
  v_lshrrev_b32 v24, 16, v16
  v_dot2c_f32_bf16 v8, v24, v128
  v_dot2c_f32_bf16 v9, v16, v128
  v_dot2c_f32_bf16 v10, v24, v129
  v_dot2c_f32_bf16 v11, v16, v129
  v_dot2c_f32_bf16 v12, v24, v130
  v_dot2c_f32_bf16 v13, v16, v130
  v_dot2c_f32_bf16 v14, v24, v131
  v_dot2c_f32_bf16 v15, v16, v131
  s_waitcnt vmcnt(6) lgkmcnt(6)
  v_lshrrev_b32 v24, 16, v17
  v_dot2c_f32_bf16 v8, v24, v132
  v_dot2c_f32_bf16 v9, v17, v132
  v_dot2c_f32_bf16 v10, v24, v133
  v_dot2c_f32_bf16 v11, v17, v133
  v_dot2c_f32_bf16 v12, v24, v134
  v_dot2c_f32_bf16 v13, v17, v134
  v_dot2c_f32_bf16 v14, v24, v135
  v_dot2c_f32_bf16 v15, v17, v135
  s_waitcnt vmcnt(5) lgkmcnt(5)
  v_lshrrev_b32 v24, 16, v18
  v_dot2c_f32_bf16 v8, v24, v136
  v_dot2c_f32_bf16 v9, v18, v136
  v_dot2c_f32_bf16 v10, v24, v137
  v_dot2c_f32_bf16 v11, v18, v137
  v_dot2c_f32_bf16 v12, v24, v138
  v_dot2c_f32_bf16 v13, v18, v138
  v_dot2c_f32_bf16 v14, v24, v139
  v_dot2c_f32_bf16 v15, v18, v139
  s_waitcnt vmcnt(4) lgkmcnt(4)
  v_lshrrev_b32 v24, 16, v19
  v_dot2c_f32_bf16 v8, v24, v140
  v_dot2c_f32_bf16 v9, v19, v140
  v_dot2c_f32_bf16 v10, v24, v141
  v_dot2c_f32_bf16 v11, v19, v141
  v_dot2c_f32_bf16 v12, v24, v142
  v_dot2c_f32_bf16 v13, v19, v142
  v_dot2c_f32_bf16 v14, v24, v143
  v_dot2c_f32_bf16 v15, v19, v143
  s_waitcnt vmcnt(3) lgkmcnt(3)
  v_lshrrev_b32 v24, 16, v20
  v_dot2c_f32_bf16 v8, v24, v144
  v_dot2c_f32_bf16 v9, v20, v144
  v_dot2c_f32_bf16 v10, v24, v145
  v_dot2c_f32_bf16 v11, v20, v145
  v_dot2c_f32_bf16 v12, v24, v146
  v_dot2c_f32_bf16 v13, v20, v146
  v_dot2c_f32_bf16 v14, v24, v147
  v_dot2c_f32_bf16 v15, v20, v147
  s_waitcnt vmcnt(2) lgkmcnt(2)
  v_lshrrev_b32 v24, 16, v21
  v_dot2c_f32_bf16 v8, v24, v148
  v_dot2c_f32_bf16 v9, v21, v148
  v_dot2c_f32_bf16 v10, v24, v149
  v_dot2c_f32_bf16 v11, v21, v149
  v_dot2c_f32_bf16 v12, v24, v150
  v_dot2c_f32_bf16 v13, v21, v150
  v_dot2c_f32_bf16 v14, v24, v151
  v_dot2c_f32_bf16 v15, v21, v151
  s_waitcnt vmcnt(1) lgkmcnt(1)
  v_lshrrev_b32 v24, 16, v22
  v_dot2c_f32_bf16 v8, v24, v152
  v_dot2c_f32_bf16 v9, v22, v152
  v_dot2c_f32_bf16 v10, v24, v153
  v_dot2c_f32_bf16 v11, v22, v153
  v_dot2c_f32_bf16 v12, v24, v154
  v_dot2c_f32_bf16 v13, v22, v154
  v_dot2c_f32_bf16 v14, v24, v155
  v_dot2c_f32_bf16 v15, v22, v155
  s_waitcnt vmcnt(0) lgkmcnt(0)
  v_lshrrev_b32 v24, 16, v23
  v_dot2c_f32_bf16 v8, v24, v156
  v_dot2c_f32_bf16 v9, v23, v156
  v_dot2c_f32_bf16 v10, v24, v157
  v_dot2c_f32_bf16 v11, v23, v157
  v_dot2c_f32_bf16 v12, v24, v158
  v_dot2c_f32_bf16 v13, v23, v158
  v_dot2c_f32_bf16 v14, v24, v159
  v_dot2c_f32_bf16 v15, v23, v159
  s_lshl_b32 s57, s6, 11
  s_add_u32 s57, s57, 131584
  v_lshlrev_b32 v176, 5, v0
  v_add_u32 v176, s57, v176
  s_nop 0
  ds_write_b128 v176, v[8:11] offset:8192
  ds_write_b128 v176, v[12:15] offset:8208
  v_mov_b32 v16, 131080
  v_mov_b32 v17, 1
  s_waitcnt lgkmcnt(0)
  s_mov_b64 exec, 1
  ds_add_u32 v16, v17
  s_mov_b64 exec, -1
  v_lshlrev_b32 v177, 3, v0
  v_add_u32 v177, 131584, v177
  v_mov_b32 v19, 131072
  s_lshl_b32 s65, s6, 14
  v_add_u32 v29, s65, v2
L_c_pre:
  s_sub_u32 s98, s98, 1
  s_cbranch_scc1 L_end
  ds_read_b32 v30, v19
  s_waitcnt lgkmcnt(0)
  v_readfirstlane_b32 s57, v30
  s_cmp_gt_u32 s57, s6
  s_cbranch_scc0 L_c_pre
  ds_read_b128 v[32:35], v29 offset:0
  ds_read_b128 v[36:39], v29 offset:1024
  ds_read_b128 v[40:43], v29 offset:2048
  ds_read_b128 v[44:47], v29 offset:3072
  ds_read_b128 v[48:51], v29 offset:4096
  ds_read_b128 v[52:55], v29 offset:5120
  ds_read_b128 v[56:59], v29 offset:6144
  ds_read_b128 v[60:63], v29 offset:7168
  ds_read_b128 v[64:67], v29 offset:8192
  ds_read_b128 v[68:71], v29 offset:9216
  ds_read_b128 v[72:75], v29 offset:10240
  ds_read_b128 v[76:79], v29 offset:11264
  ds_read_b128 v[80:83], v29 offset:12288
  ds_read_b128 v[84:87], v29 offset:13312
  ds_read_b128 v[88:91], v29 offset:14336
  ds_read_b128 v[92:95], v29 offset:15360
  s_lshl_b32 s64, s6, 2
  s_add_u32 s64, s64, 131104
  v_mov_b32 v30, s64
  v_mov_b32 v31, 1
  s_waitcnt lgkmcnt(0)
  ds_write_b32 v30, v31
L_c_qwait:
  s_sub_u32 s98, s98, 1
  s_cbranch_scc1 L_end
  ds_read_b32 v17, v16
  s_waitcnt lgkmcnt(0)
  v_readfirstlane_b32 s57, v17
  s_cmp_ge_u32 s57, 4
  s_cbranch_scc0 L_c_qwait
  ds_read_b64 v[112:113], v177 offset:8192
  ds_read_b64 v[114:115], v177 offset:8704
  ds_read_b64 v[116:117], v177 offset:9216
  ds_read_b64 v[118:119], v177 offset:9728
  ds_read_b64 v[120:121], v177 offset:10240
  ds_read_b64 v[122:123], v177 offset:10752
  ds_read_b64 v[124:125], v177 offset:11264
  ds_read_b64 v[126:127], v177 offset:11776
  ds_read_b64 v[128:129], v177 offset:12288
  ds_read_b64 v[130:131], v177 offset:12800
  ds_read_b64 v[132:133], v177 offset:13312
  ds_read_b64 v[134:135], v177 offset:13824
  ds_read_b64 v[136:137], v177 offset:14336
  ds_read_b64 v[138:139], v177 offset:14848
  ds_read_b64 v[140:141], v177 offset:15360
  ds_read_b64 v[142:143], v177 offset:15872
  s_waitcnt lgkmcnt(0)
  v_add_f32 v112, v112, v128
  v_add_f32 v113, v113, v129
  v_add_f32 v114, v114, v130
  v_add_f32 v115, v115, v131
  v_add_f32 v116, v116, v132
  v_add_f32 v117, v117, v133
  v_add_f32 v118, v118, v134
  v_add_f32 v119, v119, v135
  v_add_f32 v120, v120, v136
  v_add_f32 v121, v121, v137
  v_add_f32 v122, v122, v138
  v_add_f32 v123, v123, v139
  v_add_f32 v124, v124, v140
  v_add_f32 v125, v125, v141
  v_add_f32 v126, v126, v142
  v_add_f32 v127, v127, v143
  v_add_f32 v112, v112, v120
  v_add_f32 v113, v113, v121
  v_add_f32 v114, v114, v122
  v_add_f32 v115, v115, v123
  v_add_f32 v116, v116, v124
  v_add_f32 v117, v117, v125
  v_add_f32 v118, v118, v126
  v_add_f32 v119, v119, v127
  v_add_f32 v112, v112, v116
  v_add_f32 v113, v113, v117
  v_add_f32 v114, v114, v118
  v_add_f32 v115, v115, v119
  v_add_f32 v112, v112, v114
  v_add_f32 v113, v113, v115
  v_cvt_pk_bf16_f32 v112, v112, v113
  s_lshl_b32 s57, s6, 8
  s_add_u32 s57, s57, 150016
  v_lshlrev_b32 v16, 2, v0
  v_add_u32 v16, s57, v16
  ds_write_b32 v16, v112
  v_lshlrev_b32 v16, 4, v5
  v_add_u32 v16, s57, v16
  s_waitcnt lgkmcnt(0)
  ds_read_b128 v[4:7], v16
  s_lshl_b32 s82, s7, 10
  s_add_u32 s80, s82, 327680
  s_add_u32 s82, s82, 65536
  v_mov_b32 v8, 0
  v_mov_b32 v9, 0
  v_mov_b32 v10, 0
  v_mov_b32 v11, 0
  v_mov_b32 v12, 0
  v_mov_b32 v13, 0
  v_mov_b32 v14, 0
  v_mov_b32 v15, 0
  v_mov_b32 v16, 0
  v_mov_b32 v17, 0xff800000
  v_mov_b32 v19, 131072
  v_lshrrev_b32 v18, 2, v0
  v_lshlrev_b32 v18, 3, v18
  s_lshl_b32 s57, s6, 7
  s_add_u32 s57, s57, 131584
  v_add_u32 v18, s57, v18
  s_mov_b32 s60, 0x3fb8aa3b
  s_mov_b32 s61, 0x3db504f3
  s_mov_b32 s62, 0xffff0000
  s_mov_b32 s63, s6
  s_waitcnt lgkmcnt(0)
  s_branch L_c_Kcomp
L_c_loopK:
  ds_read_b32 v30, v19
  s_and_b32 s64, s63, 7
  s_lshl_b32 s65, s64, 14
  v_add_u32 v29, s65, v2
  s_waitcnt lgkmcnt(0)
  v_readfirstlane_b32 s57, v30
  s_cmp_gt_u32 s57, s63
  s_cbranch_scc1 L_c_goK
  s_sub_u32 s98, s98, 1
  s_cbranch_scc1 L_end
  s_sleep 4
  s_branch L_c_loopK
L_c_goK:
  ds_read_b128 v[32:35], v29 offset:0
  ds_read_b128 v[36:39], v29 offset:1024
  ds_read_b128 v[40:43], v29 offset:2048
  ds_read_b128 v[44:47], v29 offset:3072
  ds_read_b128 v[48:51], v29 offset:4096
  ds_read_b128 v[52:55], v29 offset:5120
  ds_read_b128 v[56:59], v29 offset:6144
  ds_read_b128 v[60:63], v29 offset:7168
  ds_read_b128 v[64:67], v29 offset:8192
  ds_read_b128 v[68:71], v29 offset:9216
  ds_read_b128 v[72:75], v29 offset:10240
  ds_read_b128 v[76:79], v29 offset:11264
  ds_read_b128 v[80:83], v29 offset:12288
  ds_read_b128 v[84:87], v29 offset:13312
  s_lshl_b32 s64, s64, 2
  s_add_u32 s64, s64, 131104
  s_lshr_b32 s65, s63, 3
  s_add_u32 s65, s65, 1
  v_mov_b32 v30, s64
  v_mov_b32 v31, s65
  s_waitcnt lgkmcnt(6)
  ds_read_b128 v[88:91], v29 offset:14336
  ds_read_b128 v[92:95], v29 offset:15360
L_c_Kcomp:
  v_dot2_f32_bf16 v96, v32, v4, 0
  v_dot2_f32_bf16 v97, v36, v4, 0
  v_dot2_f32_bf16 v98, v40, v4, 0
  v_dot2_f32_bf16 v99, v44, v4, 0
  v_dot2_f32_bf16 v100, v48, v4, 0
  v_dot2_f32_bf16 v101, v52, v4, 0
  v_dot2_f32_bf16 v102, v56, v4, 0
  v_dot2_f32_bf16 v103, v60, v4, 0
  v_dot2_f32_bf16 v96, v33, v5, v96
  v_dot2_f32_bf16 v97, v37, v5, v97
  v_dot2_f32_bf16 v98, v41, v5, v98
  v_dot2_f32_bf16 v99, v45, v5, v99
  v_dot2_f32_bf16 v100, v49, v5, v100
  v_dot2_f32_bf16 v101, v53, v5, v101
  v_dot2_f32_bf16 v102, v57, v5, v102
  v_dot2_f32_bf16 v103, v61, v5, v103
  v_dot2_f32_bf16 v96, v34, v6, v96
  v_dot2_f32_bf16 v97, v38, v6, v97
  v_dot2_f32_bf16 v98, v42, v6, v98
  v_dot2_f32_bf16 v99, v46, v6, v99
  v_dot2_f32_bf16 v100, v50, v6, v100
  v_dot2_f32_bf16 v101, v54, v6, v101
  v_dot2_f32_bf16 v102, v58, v6, v102
  v_dot2_f32_bf16 v103, v62, v6, v103
  v_dot2_f32_bf16 v96, v35, v7, v96
  v_dot2_f32_bf16 v97, v39, v7, v97
  v_dot2_f32_bf16 v98, v43, v7, v98
  v_dot2_f32_bf16 v99, v47, v7, v99
  v_dot2_f32_bf16 v100, v51, v7, v100
  v_dot2_f32_bf16 v101, v55, v7, v101
  v_dot2_f32_bf16 v102, v59, v7, v102
  v_dot2_f32_bf16 v103, v63, v7, v103
  s_waitcnt lgkmcnt(0)
  ds_write_b32 v30, v31
  v_dot2_f32_bf16 v104, v64, v4, 0
  v_dot2_f32_bf16 v105, v68, v4, 0
  v_dot2_f32_bf16 v106, v72, v4, 0
  v_dot2_f32_bf16 v107, v76, v4, 0
  v_dot2_f32_bf16 v108, v80, v4, 0
  v_dot2_f32_bf16 v109, v84, v4, 0
  v_dot2_f32_bf16 v110, v88, v4, 0
  v_dot2_f32_bf16 v111, v92, v4, 0
  v_dot2_f32_bf16 v104, v65, v5, v104
  v_dot2_f32_bf16 v105, v69, v5, v105
  v_dot2_f32_bf16 v106, v73, v5, v106
  v_dot2_f32_bf16 v107, v77, v5, v107
  v_dot2_f32_bf16 v108, v81, v5, v108
  v_dot2_f32_bf16 v109, v85, v5, v109
  v_dot2_f32_bf16 v110, v89, v5, v110
  v_dot2_f32_bf16 v111, v93, v5, v111
  v_dot2_f32_bf16 v104, v66, v6, v104
  v_dot2_f32_bf16 v105, v70, v6, v105
  v_dot2_f32_bf16 v106, v74, v6, v106
  v_dot2_f32_bf16 v107, v78, v6, v107
  v_dot2_f32_bf16 v108, v82, v6, v108
  v_dot2_f32_bf16 v109, v86, v6, v109
  v_dot2_f32_bf16 v110, v90, v6, v110
  v_dot2_f32_bf16 v111, v94, v6, v111
  v_dot2_f32_bf16 v104, v67, v7, v104
  v_dot2_f32_bf16 v105, v71, v7, v105
  v_dot2_f32_bf16 v106, v75, v7, v106
  v_dot2_f32_bf16 v107, v79, v7, v107
  v_dot2_f32_bf16 v108, v83, v7, v108
  v_dot2_f32_bf16 v109, v87, v7, v109
  v_dot2_f32_bf16 v110, v91, v7, v110
  v_dot2_f32_bf16 v111, v95, v7, v111
  s_nop 0
  v_add_f32_dpp v96, v96, v96 row_ror:8 row_mask:0xf bank_mask:0x3
  v_add_f32_dpp v98, v98, v98 row_ror:8 row_mask:0xf bank_mask:0x3
  v_add_f32_dpp v100, v100, v100 row_ror:8 row_mask:0xf bank_mask:0x3
  v_add_f32_dpp v102, v102, v102 row_ror:8 row_mask:0xf bank_mask:0x3
  v_add_f32_dpp v104, v104, v104 row_ror:8 row_mask:0xf bank_mask:0x3
  v_add_f32_dpp v106, v106, v106 row_ror:8 row_mask:0xf bank_mask:0x3
  v_add_f32_dpp v108, v108, v108 row_ror:8 row_mask:0xf bank_mask:0x3
  v_add_f32_dpp v110, v110, v110 row_ror:8 row_mask:0xf bank_mask:0x3
  v_add_f32_dpp v96, v97, v97 row_ror:8 row_mask:0xf bank_mask:0xc
  v_add_f32_dpp v98, v99, v99 row_ror:8 row_mask:0xf bank_mask:0xc
  v_add_f32_dpp v100, v101, v101 row_ror:8 row_mask:0xf bank_mask:0xc
  v_add_f32_dpp v102, v103, v103 row_ror:8 row_mask:0xf bank_mask:0xc
  v_add_f32_dpp v104, v105, v105 row_ror:8 row_mask:0xf bank_mask:0xc
  v_add_f32_dpp v106, v107, v107 row_ror:8 row_mask:0xf bank_mask:0xc
  v_add_f32_dpp v108, v109, v109 row_ror:8 row_mask:0xf bank_mask:0xc
  v_add_f32_dpp v110, v111, v111 row_ror:8 row_mask:0xf bank_mask:0xc
  v_add_f32_dpp v96, v96, v96 row_half_mirror row_mask:0xf bank_mask:0x5
  v_add_f32_dpp v100, v100, v100 row_half_mirror row_mask:0xf bank_mask:0x5
  v_add_f32_dpp v104, v104, v104 row_half_mirror row_mask:0xf bank_mask:0x5
  v_add_f32_dpp v108, v108, v108 row_half_mirror row_mask:0xf bank_mask:0x5
  v_add_f32_dpp v96, v98, v98 row_half_mirror row_mask:0xf bank_mask:0xa
  v_add_f32_dpp v100, v102, v102 row_half_mirror row_mask:0xf bank_mask:0xa
  v_add_f32_dpp v104, v106, v106 row_half_mirror row_mask:0xf bank_mask:0xa
  v_add_f32_dpp v108, v110, v110 row_half_mirror row_mask:0xf bank_mask:0xa
  v_add_f32_dpp v96, v96, v96 quad_perm:[1,0,3,2] row_mask:0xf bank_mask:0xf
  v_add_f32_dpp v100, v100, v100 quad_perm:[1,0,3,2] row_mask:0xf bank_mask:0xf
  v_add_f32_dpp v104, v104, v104 quad_perm:[1,0,3,2] row_mask:0xf bank_mask:0xf
  v_add_f32_dpp v108, v108, v108 quad_perm:[1,0,3,2] row_mask:0xf bank_mask:0xf
  v_add_f32_dpp v96, v96, v96 quad_perm:[2,3,0,1] row_mask:0xf bank_mask:0xf
  v_add_f32_dpp v100, v100, v100 quad_perm:[2,3,0,1] row_mask:0xf bank_mask:0xf
  v_add_f32_dpp v104, v104, v104 quad_perm:[2,3,0,1] row_mask:0xf bank_mask:0xf
  v_add_f32_dpp v108, v108, v108 quad_perm:[2,3,0,1] row_mask:0xf bank_mask:0xf
  v_cvt_pk_bf16_f32 v96, 0, v96
  v_cvt_pk_bf16_f32 v100, 0, v100
  v_cvt_pk_bf16_f32 v104, 0, v104
  v_cvt_pk_bf16_f32 v108, 0, v108
  v_mul_f32 v96, s61, v96
  v_mul_f32 v100, s61, v100
  v_mul_f32 v104, s61, v104
  v_mul_f32 v108, s61, v108
  v_cvt_pk_bf16_f32 v20, v96, v100
  v_cvt_pk_bf16_f32 v21, v104, v108
  ds_write_b64 v18, v[20:21]
  v_lshlrev_b32 v22, 16, v20
  v_and_b32 v23, s62, v20
  v_lshlrev_b32 v24, 16, v21
  v_and_b32 v25, s62, v21
  v_add_u32 v18, 512, v18
  v_max_f32 v26, v22, v23
  v_max3_f32 v26, v24, v25, v26
  v_cmp_gt_f32 vcc, v26, v17
  s_cbranch_vccnz L_c_newmax
L_c_cont:
  v_sub_f32 v22, v22, v17
  v_sub_f32 v23, v23, v17
  v_sub_f32 v24, v24, v17
  v_sub_f32 v25, v25, v17
  v_mul_f32 v22, s60, v22
  v_mul_f32 v23, s60, v23
  v_mul_f32 v24, s60, v24
  v_mul_f32 v25, s60, v25
  v_exp_f32 v22, v22
  v_exp_f32 v23, v23
  v_exp_f32 v24, v24
  v_exp_f32 v25, v25
  s_add_u32 s63, s63, 4
  v_add_f32 v22, v22, v23
  v_add_f32 v24, v24, v25
  s_cmp_lt_u32 s63, 128
  v_add_f32 v22, v22, v24
  v_add_f32 v16, v16, v22
  s_cbranch_scc1 L_c_loopK
  s_branch L_c_mid
L_c_newmax:
  s_nop 0
  v_max_f32_dpp v26, v26, v26 row_ror:4 row_mask:0xf bank_mask:0xf
  s_nop 1
  v_max_f32_dpp v26, v26, v26 row_ror:8 row_mask:0xf bank_mask:0xf
  s_nop 0
  v_readlane_b32 s64, v26, 0
  v_readlane_b32 s65, v26, 16
  v_readlane_b32 s66, v26, 32
  v_readlane_b32 s67, v26, 48
  v_mov_b32 v27, v17
  s_nop 0
  v_max_f32 v17, s64, v17
  v_max_f32 v17, s65, v17
  v_max_f32 v17, s66, v17
  v_max_f32 v17, s67, v17
  v_sub_f32 v27, v27, v17
  v_mul_f32 v27, s60, v27
  v_exp_f32 v27, v27
  s_nop 0
  v_mul_f32 v16, v16, v27
  s_branch L_c_cont
L_c_mid:
  s_nop 1
  v_add_f32_dpp v16, v16, v16 row_ror:4 row_mask:0xf bank_mask:0xf
  s_nop 1
  v_add_f32_dpp v16, v16, v16 row_ror:8 row_mask:0xf bank_mask:0xf
  s_nop 0
  v_readlane_b32 s64, v16, 0
  v_readlane_b32 s65, v16, 16
  v_readlane_b32 s66, v16, 32
  v_readlane_b32 s67, v16, 48
  s_nop 1
  v_mov_b32 v16, s64
  v_mov_b32 v20, s66
  v_add_f32 v16, s65, v16
  v_add_f32 v20, s67, v20
  v_add_f32 v16, v16, v20
  s_lshl_b32 s57, s6, 3
  s_add_u32 s57, s57, 131200
  v_mov_b32 v22, s57
  v_mov_b32 v20, v17
  v_mov_b32 v21, v16
  ds_write_b64 v22, v[20:21]
  v_mov_b32 v22, 131084
  v_mov_b32 v23, 1
  v_subrev_u32 v18, 16384, v18
  s_waitcnt lgkmcnt(0)
  s_mov_b64 exec, 1
  ds_add_u32 v22, v23
  s_mov_b64 exec, -1
  v_mov_b32 v22, 131088
L_c_gwait:
  s_sub_u32 s98, s98, 1
  s_cbranch_scc1 L_end
  s_sleep 1
  ds_read_b128 v[24:27], v22
  s_waitcnt lgkmcnt(0)
  v_readfirstlane_b32 s57, v24
  s_cmp_eq_u32 s57, 1
  s_cbranch_scc0 L_c_gwait
  v_mov_b32 v17, v25
  v_mov_b32 v16, v26
L_c_loopV:
  ds_read_b32 v30, v19
  s_and_b32 s64, s63, 7
  s_lshl_b32 s65, s64, 14
  v_add_u32 v29, s65, v2
  s_waitcnt lgkmcnt(0)
  v_readfirstlane_b32 s57, v30
  s_cmp_gt_u32 s57, s63
  s_cbranch_scc1 L_c_goV
  s_sub_u32 s98, s98, 1
  s_cbranch_scc1 L_end
  s_sleep 4
  s_branch L_c_loopV
L_c_goV:
  ds_read_b64 v[20:21], v18
  ds_read_b128 v[32:35], v29 offset:0
  ds_read_b128 v[36:39], v29 offset:1024
  ds_read_b128 v[40:43], v29 offset:2048
  ds_read_b128 v[44:47], v29 offset:3072
  ds_read_b128 v[48:51], v29 offset:4096
  ds_read_b128 v[52:55], v29 offset:5120
  ds_read_b128 v[56:59], v29 offset:6144
  ds_read_b128 v[60:63], v29 offset:7168
  ds_read_b128 v[64:67], v29 offset:8192
  ds_read_b128 v[68:71], v29 offset:9216
  ds_read_b128 v[72:75], v29 offset:10240
  ds_read_b128 v[76:79], v29 offset:11264
  ds_read_b128 v[80:83], v29 offset:12288
  ds_read_b128 v[84:87], v29 offset:13312
  s_lshl_b32 s64, s64, 2
  s_add_u32 s64, s64, 131104
  s_lshr_b32 s65, s63, 3
  s_add_u32 s65, s65, 1
  v_mov_b32 v30, s64
  v_mov_b32 v31, s65
  s_waitcnt lgkmcnt(13)
  ds_read_b128 v[88:91], v29 offset:14336
  ds_read_b128 v[92:95], v29 offset:15360
  v_lshlrev_b32 v22, 16, v20
  v_and_b32 v23, s62, v20
  v_lshlrev_b32 v24, 16, v21
  v_and_b32 v25, s62, v21
  v_add_u32 v18, 512, v18
  v_sub_f32 v22, v22, v17
  v_sub_f32 v23, v23, v17
  v_sub_f32 v24, v24, v17
  v_sub_f32 v25, v25, v17
  v_mul_f32 v22, s60, v22
  v_mul_f32 v23, s60, v23
  v_mul_f32 v24, s60, v24
  v_mul_f32 v25, s60, v25
  v_exp_f32 v22, v22
  v_exp_f32 v23, v23
  v_exp_f32 v24, v24
  v_exp_f32 v25, v25
  s_nop 0
  v_mul_f32 v22, v22, v16
  v_mul_f32 v23, v23, v16
  v_mul_f32 v24, v24, v16
  v_mul_f32 v25, v25, v16
  v_cvt_pk_bf16_f32 v96, v22, 0
  v_cvt_pk_bf16_f32 v97, 0, v22
  v_cvt_pk_bf16_f32 v98, v23, 0
  v_cvt_pk_bf16_f32 v99, 0, v23
  v_cvt_pk_bf16_f32 v100, v24, 0
  v_cvt_pk_bf16_f32 v101, 0, v24
  v_cvt_pk_bf16_f32 v102, v25, 0
  v_cvt_pk_bf16_f32 v103, 0, v25
  s_waitcnt lgkmcnt(8)
  v_dot2c_f32_bf16_dpp v8, v96, v32 row_newbcast:0 row_mask:0xf bank_mask:0xf
  v_dot2c_f32_bf16_dpp v9, v97, v32 row_newbcast:0 row_mask:0xf bank_mask:0xf
  v_dot2c_f32_bf16_dpp v10, v96, v33 row_newbcast:0 row_mask:0xf bank_mask:0xf
  v_dot2c_f32_bf16_dpp v11, v97, v33 row_newbcast:0 row_mask:0xf bank_mask:0xf
  v_dot2c_f32_bf16_dpp v12, v96, v34 row_newbcast:0 row_mask:0xf bank_mask:0xf
  v_dot2c_f32_bf16_dpp v13, v97, v34 row_newbcast:0 row_mask:0xf bank_mask:0xf
  v_dot2c_f32_bf16_dpp v14, v96, v35 row_newbcast:0 row_mask:0xf bank_mask:0xf
  v_dot2c_f32_bf16_dpp v15, v97, v35 row_newbcast:0 row_mask:0xf bank_mask:0xf
  v_dot2c_f32_bf16_dpp v8, v96, v36 row_newbcast:8 row_mask:0xf bank_mask:0xf
  v_dot2c_f32_bf16_dpp v9, v97, v36 row_newbcast:8 row_mask:0xf bank_mask:0xf
  v_dot2c_f32_bf16_dpp v10, v96, v37 row_newbcast:8 row_mask:0xf bank_mask:0xf
  v_dot2c_f32_bf16_dpp v11, v97, v37 row_newbcast:8 row_mask:0xf bank_mask:0xf
  v_dot2c_f32_bf16_dpp v12, v96, v38 row_newbcast:8 row_mask:0xf bank_mask:0xf
  v_dot2c_f32_bf16_dpp v13, v97, v38 row_newbcast:8 row_mask:0xf bank_mask:0xf
  v_dot2c_f32_bf16_dpp v14, v96, v39 row_newbcast:8 row_mask:0xf bank_mask:0xf
  v_dot2c_f32_bf16_dpp v15, v97, v39 row_newbcast:8 row_mask:0xf bank_mask:0xf
  v_dot2c_f32_bf16_dpp v8, v96, v40 row_newbcast:4 row_mask:0xf bank_mask:0xf
  v_dot2c_f32_bf16_dpp v9, v97, v40 row_newbcast:4 row_mask:0xf bank_mask:0xf
  v_dot2c_f32_bf16_dpp v10, v96, v41 row_newbcast:4 row_mask:0xf bank_mask:0xf
  v_dot2c_f32_bf16_dpp v11, v97, v41 row_newbcast:4 row_mask:0xf bank_mask:0xf
  v_dot2c_f32_bf16_dpp v12, v96, v42 row_newbcast:4 row_mask:0xf bank_mask:0xf
  v_dot2c_f32_bf16_dpp v13, v97, v42 row_newbcast:4 row_mask:0xf bank_mask:0xf
  v_dot2c_f32_bf16_dpp v14, v96, v43 row_newbcast:4 row_mask:0xf bank_mask:0xf
  v_dot2c_f32_bf16_dpp v15, v97, v43 row_newbcast:4 row_mask:0xf bank_mask:0xf
  v_dot2c_f32_bf16_dpp v8, v96, v44 row_newbcast:12 row_mask:0xf bank_mask:0xf
  v_dot2c_f32_bf16_dpp v9, v97, v44 row_newbcast:12 row_mask:0xf bank_mask:0xf
  v_dot2c_f32_bf16_dpp v10, v96, v45 row_newbcast:12 row_mask:0xf bank_mask:0xf
  v_dot2c_f32_bf16_dpp v11, v97, v45 row_newbcast:12 row_mask:0xf bank_mask:0xf
  v_dot2c_f32_bf16_dpp v12, v96, v46 row_newbcast:12 row_mask:0xf bank_mask:0xf
  v_dot2c_f32_bf16_dpp v13, v97, v46 row_newbcast:12 row_mask:0xf bank_mask:0xf
  v_dot2c_f32_bf16_dpp v14, v96, v47 row_newbcast:12 row_mask:0xf bank_mask:0xf
  v_dot2c_f32_bf16_dpp v15, v97, v47 row_newbcast:12 row_mask:0xf bank_mask:0xf
  v_dot2c_f32_bf16_dpp v8, v98, v48 row_newbcast:0 row_mask:0xf bank_mask:0xf
  v_dot2c_f32_bf16_dpp v9, v99, v48 row_newbcast:0 row_mask:0xf bank_mask:0xf
  v_dot2c_f32_bf16_dpp v10, v98, v49 row_newbcast:0 row_mask:0xf bank_mask:0xf
  v_dot2c_f32_bf16_dpp v11, v99, v49 row_newbcast:0 row_mask:0xf bank_mask:0xf
  v_dot2c_f32_bf16_dpp v12, v98, v50 row_newbcast:0 row_mask:0xf bank_mask:0xf
  v_dot2c_f32_bf16_dpp v13, v99, v50 row_newbcast:0 row_mask:0xf bank_mask:0xf
  v_dot2c_f32_bf16_dpp v14, v98, v51 row_newbcast:0 row_mask:0xf bank_mask:0xf
  v_dot2c_f32_bf16_dpp v15, v99, v51 row_newbcast:0 row_mask:0xf bank_mask:0xf
  v_dot2c_f32_bf16_dpp v8, v98, v52 row_newbcast:8 row_mask:0xf bank_mask:0xf
  v_dot2c_f32_bf16_dpp v9, v99, v52 row_newbcast:8 row_mask:0xf bank_mask:0xf
  v_dot2c_f32_bf16_dpp v10, v98, v53 row_newbcast:8 row_mask:0xf bank_mask:0xf
  v_dot2c_f32_bf16_dpp v11, v99, v53 row_newbcast:8 row_mask:0xf bank_mask:0xf
  v_dot2c_f32_bf16_dpp v12, v98, v54 row_newbcast:8 row_mask:0xf bank_mask:0xf
  v_dot2c_f32_bf16_dpp v13, v99, v54 row_newbcast:8 row_mask:0xf bank_mask:0xf
  v_dot2c_f32_bf16_dpp v14, v98, v55 row_newbcast:8 row_mask:0xf bank_mask:0xf
  v_dot2c_f32_bf16_dpp v15, v99, v55 row_newbcast:8 row_mask:0xf bank_mask:0xf
  v_dot2c_f32_bf16_dpp v8, v98, v56 row_newbcast:4 row_mask:0xf bank_mask:0xf
  v_dot2c_f32_bf16_dpp v9, v99, v56 row_newbcast:4 row_mask:0xf bank_mask:0xf
  v_dot2c_f32_bf16_dpp v10, v98, v57 row_newbcast:4 row_mask:0xf bank_mask:0xf
  v_dot2c_f32_bf16_dpp v11, v99, v57 row_newbcast:4 row_mask:0xf bank_mask:0xf
  v_dot2c_f32_bf16_dpp v12, v98, v58 row_newbcast:4 row_mask:0xf bank_mask:0xf
  v_dot2c_f32_bf16_dpp v13, v99, v58 row_newbcast:4 row_mask:0xf bank_mask:0xf
  v_dot2c_f32_bf16_dpp v14, v98, v59 row_newbcast:4 row_mask:0xf bank_mask:0xf
  v_dot2c_f32_bf16_dpp v15, v99, v59 row_newbcast:4 row_mask:0xf bank_mask:0xf
  v_dot2c_f32_bf16_dpp v8, v98, v60 row_newbcast:12 row_mask:0xf bank_mask:0xf
  v_dot2c_f32_bf16_dpp v9, v99, v60 row_newbcast:12 row_mask:0xf bank_mask:0xf
  v_dot2c_f32_bf16_dpp v10, v98, v61 row_newbcast:12 row_mask:0xf bank_mask:0xf
  v_dot2c_f32_bf16_dpp v11, v99, v61 row_newbcast:12 row_mask:0xf bank_mask:0xf
  v_dot2c_f32_bf16_dpp v12, v98, v62 row_newbcast:12 row_mask:0xf bank_mask:0xf
  v_dot2c_f32_bf16_dpp v13, v99, v62 row_newbcast:12 row_mask:0xf bank_mask:0xf
  v_dot2c_f32_bf16_dpp v14, v98, v63 row_newbcast:12 row_mask:0xf bank_mask:0xf
  v_dot2c_f32_bf16_dpp v15, v99, v63 row_newbcast:12 row_mask:0xf bank_mask:0xf
  s_waitcnt lgkmcnt(0)
  ds_write_b32 v30, v31
  v_dot2c_f32_bf16_dpp v8, v100, v64 row_newbcast:0 row_mask:0xf bank_mask:0xf
  v_dot2c_f32_bf16_dpp v9, v101, v64 row_newbcast:0 row_mask:0xf bank_mask:0xf
  v_dot2c_f32_bf16_dpp v10, v100, v65 row_newbcast:0 row_mask:0xf bank_mask:0xf
  v_dot2c_f32_bf16_dpp v11, v101, v65 row_newbcast:0 row_mask:0xf bank_mask:0xf
  v_dot2c_f32_bf16_dpp v12, v100, v66 row_newbcast:0 row_mask:0xf bank_mask:0xf
  v_dot2c_f32_bf16_dpp v13, v101, v66 row_newbcast:0 row_mask:0xf bank_mask:0xf
  v_dot2c_f32_bf16_dpp v14, v100, v67 row_newbcast:0 row_mask:0xf bank_mask:0xf
  v_dot2c_f32_bf16_dpp v15, v101, v67 row_newbcast:0 row_mask:0xf bank_mask:0xf
  v_dot2c_f32_bf16_dpp v8, v100, v68 row_newbcast:8 row_mask:0xf bank_mask:0xf
  v_dot2c_f32_bf16_dpp v9, v101, v68 row_newbcast:8 row_mask:0xf bank_mask:0xf
  v_dot2c_f32_bf16_dpp v10, v100, v69 row_newbcast:8 row_mask:0xf bank_mask:0xf
  v_dot2c_f32_bf16_dpp v11, v101, v69 row_newbcast:8 row_mask:0xf bank_mask:0xf
  v_dot2c_f32_bf16_dpp v12, v100, v70 row_newbcast:8 row_mask:0xf bank_mask:0xf
  v_dot2c_f32_bf16_dpp v13, v101, v70 row_newbcast:8 row_mask:0xf bank_mask:0xf
  v_dot2c_f32_bf16_dpp v14, v100, v71 row_newbcast:8 row_mask:0xf bank_mask:0xf
  v_dot2c_f32_bf16_dpp v15, v101, v71 row_newbcast:8 row_mask:0xf bank_mask:0xf
  v_dot2c_f32_bf16_dpp v8, v100, v72 row_newbcast:4 row_mask:0xf bank_mask:0xf
  v_dot2c_f32_bf16_dpp v9, v101, v72 row_newbcast:4 row_mask:0xf bank_mask:0xf
  v_dot2c_f32_bf16_dpp v10, v100, v73 row_newbcast:4 row_mask:0xf bank_mask:0xf
  v_dot2c_f32_bf16_dpp v11, v101, v73 row_newbcast:4 row_mask:0xf bank_mask:0xf
  v_dot2c_f32_bf16_dpp v12, v100, v74 row_newbcast:4 row_mask:0xf bank_mask:0xf
  v_dot2c_f32_bf16_dpp v13, v101, v74 row_newbcast:4 row_mask:0xf bank_mask:0xf
  v_dot2c_f32_bf16_dpp v14, v100, v75 row_newbcast:4 row_mask:0xf bank_mask:0xf
  v_dot2c_f32_bf16_dpp v15, v101, v75 row_newbcast:4 row_mask:0xf bank_mask:0xf
  v_dot2c_f32_bf16_dpp v8, v100, v76 row_newbcast:12 row_mask:0xf bank_mask:0xf
  v_dot2c_f32_bf16_dpp v9, v101, v76 row_newbcast:12 row_mask:0xf bank_mask:0xf
  v_dot2c_f32_bf16_dpp v10, v100, v77 row_newbcast:12 row_mask:0xf bank_mask:0xf
  v_dot2c_f32_bf16_dpp v11, v101, v77 row_newbcast:12 row_mask:0xf bank_mask:0xf
  v_dot2c_f32_bf16_dpp v12, v100, v78 row_newbcast:12 row_mask:0xf bank_mask:0xf
  v_dot2c_f32_bf16_dpp v13, v101, v78 row_newbcast:12 row_mask:0xf bank_mask:0xf
  v_dot2c_f32_bf16_dpp v14, v100, v79 row_newbcast:12 row_mask:0xf bank_mask:0xf
  v_dot2c_f32_bf16_dpp v15, v101, v79 row_newbcast:12 row_mask:0xf bank_mask:0xf
  v_dot2c_f32_bf16_dpp v8, v102, v80 row_newbcast:0 row_mask:0xf bank_mask:0xf
  v_dot2c_f32_bf16_dpp v9, v103, v80 row_newbcast:0 row_mask:0xf bank_mask:0xf
  v_dot2c_f32_bf16_dpp v10, v102, v81 row_newbcast:0 row_mask:0xf bank_mask:0xf
  v_dot2c_f32_bf16_dpp v11, v103, v81 row_newbcast:0 row_mask:0xf bank_mask:0xf
  v_dot2c_f32_bf16_dpp v12, v102, v82 row_newbcast:0 row_mask:0xf bank_mask:0xf
  v_dot2c_f32_bf16_dpp v13, v103, v82 row_newbcast:0 row_mask:0xf bank_mask:0xf
  v_dot2c_f32_bf16_dpp v14, v102, v83 row_newbcast:0 row_mask:0xf bank_mask:0xf
  v_dot2c_f32_bf16_dpp v15, v103, v83 row_newbcast:0 row_mask:0xf bank_mask:0xf
  v_dot2c_f32_bf16_dpp v8, v102, v84 row_newbcast:8 row_mask:0xf bank_mask:0xf
  v_dot2c_f32_bf16_dpp v9, v103, v84 row_newbcast:8 row_mask:0xf bank_mask:0xf
  v_dot2c_f32_bf16_dpp v10, v102, v85 row_newbcast:8 row_mask:0xf bank_mask:0xf
  v_dot2c_f32_bf16_dpp v11, v103, v85 row_newbcast:8 row_mask:0xf bank_mask:0xf
  v_dot2c_f32_bf16_dpp v12, v102, v86 row_newbcast:8 row_mask:0xf bank_mask:0xf
  v_dot2c_f32_bf16_dpp v13, v103, v86 row_newbcast:8 row_mask:0xf bank_mask:0xf
  v_dot2c_f32_bf16_dpp v14, v102, v87 row_newbcast:8 row_mask:0xf bank_mask:0xf
  v_dot2c_f32_bf16_dpp v15, v103, v87 row_newbcast:8 row_mask:0xf bank_mask:0xf
  v_dot2c_f32_bf16_dpp v8, v102, v88 row_newbcast:4 row_mask:0xf bank_mask:0xf
  v_dot2c_f32_bf16_dpp v9, v103, v88 row_newbcast:4 row_mask:0xf bank_mask:0xf
  v_dot2c_f32_bf16_dpp v10, v102, v89 row_newbcast:4 row_mask:0xf bank_mask:0xf
  v_dot2c_f32_bf16_dpp v11, v103, v89 row_newbcast:4 row_mask:0xf bank_mask:0xf
  v_dot2c_f32_bf16_dpp v12, v102, v90 row_newbcast:4 row_mask:0xf bank_mask:0xf
  v_dot2c_f32_bf16_dpp v13, v103, v90 row_newbcast:4 row_mask:0xf bank_mask:0xf
  v_dot2c_f32_bf16_dpp v14, v102, v91 row_newbcast:4 row_mask:0xf bank_mask:0xf
  v_dot2c_f32_bf16_dpp v15, v103, v91 row_newbcast:4 row_mask:0xf bank_mask:0xf
  v_dot2c_f32_bf16_dpp v8, v102, v92 row_newbcast:12 row_mask:0xf bank_mask:0xf
  v_dot2c_f32_bf16_dpp v9, v103, v92 row_newbcast:12 row_mask:0xf bank_mask:0xf
  v_dot2c_f32_bf16_dpp v10, v102, v93 row_newbcast:12 row_mask:0xf bank_mask:0xf
  v_dot2c_f32_bf16_dpp v11, v103, v93 row_newbcast:12 row_mask:0xf bank_mask:0xf
  v_dot2c_f32_bf16_dpp v12, v102, v94 row_newbcast:12 row_mask:0xf bank_mask:0xf
  v_dot2c_f32_bf16_dpp v13, v103, v94 row_newbcast:12 row_mask:0xf bank_mask:0xf
  v_dot2c_f32_bf16_dpp v14, v102, v95 row_newbcast:12 row_mask:0xf bank_mask:0xf
  v_dot2c_f32_bf16_dpp v15, v103, v95 row_newbcast:12 row_mask:0xf bank_mask:0xf
  s_add_u32 s63, s63, 4
  s_cmp_lt_u32 s63, 252
  s_cbranch_scc1 L_c_loopV
  v_lshrrev_b32 v18, 2, v0
  v_lshlrev_b32 v18, 3, v18
  s_lshl_b32 s57, s6, 1
  s_add_u32 s57, s57, 147456
  v_add_u32 v18, s57, v18
  ds_read_u16 v22, v18 offset:0
  ds_read_u16 v23, v18 offset:128
  ds_read_u16 v24, v18 offset:256
  ds_read_u16 v25, v18 offset:384
  s_lshl_b32 s57, s6, 12
  s_add_u32 s57, s57, 65536
  v_add_u32 v29, s57, v2
  s_waitcnt lgkmcnt(0)
  v_lshlrev_b32 v22, 16, v22
  v_lshlrev_b32 v23, 16, v23
  v_lshlrev_b32 v24, 16, v24
  v_lshlrev_b32 v25, 16, v25
  v_sub_f32 v22, v22, v17
  v_sub_f32 v23, v23, v17
  v_sub_f32 v24, v24, v17
  v_sub_f32 v25, v25, v17
  v_mul_f32 v22, s60, v22
  v_mul_f32 v23, s60, v23
  v_mul_f32 v24, s60, v24
  v_mul_f32 v25, s60, v25
  v_exp_f32 v22, v22
  v_exp_f32 v23, v23
  v_exp_f32 v24, v24
  v_exp_f32 v25, v25
  s_nop 0
  v_mul_f32 v22, v22, v16
  v_mul_f32 v23, v23, v16
  v_mul_f32 v24, v24, v16
  v_mul_f32 v25, v25, v16
  v_cvt_pk_bf16_f32 v96, v22, 0
  v_cvt_pk_bf16_f32 v97, 0, v22
  v_cvt_pk_bf16_f32 v98, v23, 0
  v_cvt_pk_bf16_f32 v99, 0, v23
  v_cvt_pk_bf16_f32 v100, v24, 0
  v_cvt_pk_bf16_f32 v101, 0, v24
  v_cvt_pk_bf16_f32 v102, v25, 0
  v_cvt_pk_bf16_f32 v103, 0, v25
L_c_q0:
  ds_read_b32 v30, v19
  s_waitcnt lgkmcnt(0)
  v_readfirstlane_b32 s57, v30
  s_cmp_gt_u32 s57, 252
  s_cbranch_scc1 L_c_qg0
  s_sub_u32 s98, s98, 1
  s_cbranch_scc1 L_end
  s_branch L_c_q0
L_c_qg0:
  ds_read_b128 v[32:35], v29 offset:0
  ds_read_b128 v[36:39], v29 offset:1024
  ds_read_b128 v[40:43], v29 offset:2048
  ds_read_b128 v[44:47], v29 offset:3072
  s_waitcnt lgkmcnt(3)
  v_dot2c_f32_bf16_dpp v8, v96, v32 row_newbcast:0 row_mask:0xf bank_mask:0xf
  v_dot2c_f32_bf16_dpp v9, v97, v32 row_newbcast:0 row_mask:0xf bank_mask:0xf
  v_dot2c_f32_bf16_dpp v10, v96, v33 row_newbcast:0 row_mask:0xf bank_mask:0xf
  v_dot2c_f32_bf16_dpp v11, v97, v33 row_newbcast:0 row_mask:0xf bank_mask:0xf
  v_dot2c_f32_bf16_dpp v12, v96, v34 row_newbcast:0 row_mask:0xf bank_mask:0xf
  v_dot2c_f32_bf16_dpp v13, v97, v34 row_newbcast:0 row_mask:0xf bank_mask:0xf
  v_dot2c_f32_bf16_dpp v14, v96, v35 row_newbcast:0 row_mask:0xf bank_mask:0xf
  v_dot2c_f32_bf16_dpp v15, v97, v35 row_newbcast:0 row_mask:0xf bank_mask:0xf
  s_waitcnt lgkmcnt(2)
  v_dot2c_f32_bf16_dpp v8, v96, v36 row_newbcast:8 row_mask:0xf bank_mask:0xf
  v_dot2c_f32_bf16_dpp v9, v97, v36 row_newbcast:8 row_mask:0xf bank_mask:0xf
  v_dot2c_f32_bf16_dpp v10, v96, v37 row_newbcast:8 row_mask:0xf bank_mask:0xf
  v_dot2c_f32_bf16_dpp v11, v97, v37 row_newbcast:8 row_mask:0xf bank_mask:0xf
  v_dot2c_f32_bf16_dpp v12, v96, v38 row_newbcast:8 row_mask:0xf bank_mask:0xf
  v_dot2c_f32_bf16_dpp v13, v97, v38 row_newbcast:8 row_mask:0xf bank_mask:0xf
  v_dot2c_f32_bf16_dpp v14, v96, v39 row_newbcast:8 row_mask:0xf bank_mask:0xf
  v_dot2c_f32_bf16_dpp v15, v97, v39 row_newbcast:8 row_mask:0xf bank_mask:0xf
  s_waitcnt lgkmcnt(1)
  v_dot2c_f32_bf16_dpp v8, v96, v40 row_newbcast:4 row_mask:0xf bank_mask:0xf
  v_dot2c_f32_bf16_dpp v9, v97, v40 row_newbcast:4 row_mask:0xf bank_mask:0xf
  v_dot2c_f32_bf16_dpp v10, v96, v41 row_newbcast:4 row_mask:0xf bank_mask:0xf
  v_dot2c_f32_bf16_dpp v11, v97, v41 row_newbcast:4 row_mask:0xf bank_mask:0xf
  v_dot2c_f32_bf16_dpp v12, v96, v42 row_newbcast:4 row_mask:0xf bank_mask:0xf
  v_dot2c_f32_bf16_dpp v13, v97, v42 row_newbcast:4 row_mask:0xf bank_mask:0xf
  v_dot2c_f32_bf16_dpp v14, v96, v43 row_newbcast:4 row_mask:0xf bank_mask:0xf
  v_dot2c_f32_bf16_dpp v15, v97, v43 row_newbcast:4 row_mask:0xf bank_mask:0xf
  s_waitcnt lgkmcnt(0)
  v_dot2c_f32_bf16_dpp v8, v96, v44 row_newbcast:12 row_mask:0xf bank_mask:0xf
  v_dot2c_f32_bf16_dpp v9, v97, v44 row_newbcast:12 row_mask:0xf bank_mask:0xf
  v_dot2c_f32_bf16_dpp v10, v96, v45 row_newbcast:12 row_mask:0xf bank_mask:0xf
  v_dot2c_f32_bf16_dpp v11, v97, v45 row_newbcast:12 row_mask:0xf bank_mask:0xf
  v_dot2c_f32_bf16_dpp v12, v96, v46 row_newbcast:12 row_mask:0xf bank_mask:0xf
  v_dot2c_f32_bf16_dpp v13, v97, v46 row_newbcast:12 row_mask:0xf bank_mask:0xf
  v_dot2c_f32_bf16_dpp v14, v96, v47 row_newbcast:12 row_mask:0xf bank_mask:0xf
  v_dot2c_f32_bf16_dpp v15, v97, v47 row_newbcast:12 row_mask:0xf bank_mask:0xf
L_c_q1:
  ds_read_b32 v30, v19
  s_waitcnt lgkmcnt(0)
  v_readfirstlane_b32 s57, v30
  s_cmp_gt_u32 s57, 253
  s_cbranch_scc1 L_c_qg1
  s_sub_u32 s98, s98, 1
  s_cbranch_scc1 L_end
  s_branch L_c_q1
L_c_qg1:
  ds_read_b128 v[32:35], v29 offset:16384
  ds_read_b128 v[36:39], v29 offset:17408
  ds_read_b128 v[40:43], v29 offset:18432
  ds_read_b128 v[44:47], v29 offset:19456
  s_waitcnt lgkmcnt(3)
  v_dot2c_f32_bf16_dpp v8, v98, v32 row_newbcast:0 row_mask:0xf bank_mask:0xf
  v_dot2c_f32_bf16_dpp v9, v99, v32 row_newbcast:0 row_mask:0xf bank_mask:0xf
  v_dot2c_f32_bf16_dpp v10, v98, v33 row_newbcast:0 row_mask:0xf bank_mask:0xf
  v_dot2c_f32_bf16_dpp v11, v99, v33 row_newbcast:0 row_mask:0xf bank_mask:0xf
  v_dot2c_f32_bf16_dpp v12, v98, v34 row_newbcast:0 row_mask:0xf bank_mask:0xf
  v_dot2c_f32_bf16_dpp v13, v99, v34 row_newbcast:0 row_mask:0xf bank_mask:0xf
  v_dot2c_f32_bf16_dpp v14, v98, v35 row_newbcast:0 row_mask:0xf bank_mask:0xf
  v_dot2c_f32_bf16_dpp v15, v99, v35 row_newbcast:0 row_mask:0xf bank_mask:0xf
  s_waitcnt lgkmcnt(2)
  v_dot2c_f32_bf16_dpp v8, v98, v36 row_newbcast:8 row_mask:0xf bank_mask:0xf
  v_dot2c_f32_bf16_dpp v9, v99, v36 row_newbcast:8 row_mask:0xf bank_mask:0xf
  v_dot2c_f32_bf16_dpp v10, v98, v37 row_newbcast:8 row_mask:0xf bank_mask:0xf
  v_dot2c_f32_bf16_dpp v11, v99, v37 row_newbcast:8 row_mask:0xf bank_mask:0xf
  v_dot2c_f32_bf16_dpp v12, v98, v38 row_newbcast:8 row_mask:0xf bank_mask:0xf
  v_dot2c_f32_bf16_dpp v13, v99, v38 row_newbcast:8 row_mask:0xf bank_mask:0xf
  v_dot2c_f32_bf16_dpp v14, v98, v39 row_newbcast:8 row_mask:0xf bank_mask:0xf
  v_dot2c_f32_bf16_dpp v15, v99, v39 row_newbcast:8 row_mask:0xf bank_mask:0xf
  s_waitcnt lgkmcnt(1)
  v_dot2c_f32_bf16_dpp v8, v98, v40 row_newbcast:4 row_mask:0xf bank_mask:0xf
  v_dot2c_f32_bf16_dpp v9, v99, v40 row_newbcast:4 row_mask:0xf bank_mask:0xf
  v_dot2c_f32_bf16_dpp v10, v98, v41 row_newbcast:4 row_mask:0xf bank_mask:0xf
  v_dot2c_f32_bf16_dpp v11, v99, v41 row_newbcast:4 row_mask:0xf bank_mask:0xf
  v_dot2c_f32_bf16_dpp v12, v98, v42 row_newbcast:4 row_mask:0xf bank_mask:0xf
  v_dot2c_f32_bf16_dpp v13, v99, v42 row_newbcast:4 row_mask:0xf bank_mask:0xf
  v_dot2c_f32_bf16_dpp v14, v98, v43 row_newbcast:4 row_mask:0xf bank_mask:0xf
  v_dot2c_f32_bf16_dpp v15, v99, v43 row_newbcast:4 row_mask:0xf bank_mask:0xf
  s_waitcnt lgkmcnt(0)
  v_dot2c_f32_bf16_dpp v8, v98, v44 row_newbcast:12 row_mask:0xf bank_mask:0xf
  v_dot2c_f32_bf16_dpp v9, v99, v44 row_newbcast:12 row_mask:0xf bank_mask:0xf
  v_dot2c_f32_bf16_dpp v10, v98, v45 row_newbcast:12 row_mask:0xf bank_mask:0xf
  v_dot2c_f32_bf16_dpp v11, v99, v45 row_newbcast:12 row_mask:0xf bank_mask:0xf
  v_dot2c_f32_bf16_dpp v12, v98, v46 row_newbcast:12 row_mask:0xf bank_mask:0xf
  v_dot2c_f32_bf16_dpp v13, v99, v46 row_newbcast:12 row_mask:0xf bank_mask:0xf
  v_dot2c_f32_bf16_dpp v14, v98, v47 row_newbcast:12 row_mask:0xf bank_mask:0xf
  v_dot2c_f32_bf16_dpp v15, v99, v47 row_newbcast:12 row_mask:0xf bank_mask:0xf
L_c_q2:
  ds_read_b32 v30, v19
  s_waitcnt lgkmcnt(0)
  v_readfirstlane_b32 s57, v30
  s_cmp_gt_u32 s57, 254
  s_cbranch_scc1 L_c_qg2
  s_sub_u32 s98, s98, 1
  s_cbranch_scc1 L_end
  s_branch L_c_q2
L_c_qg2:
  ds_read_b128 v[32:35], v29 offset:32768
  ds_read_b128 v[36:39], v29 offset:33792
  ds_read_b128 v[40:43], v29 offset:34816
  ds_read_b128 v[44:47], v29 offset:35840
  s_waitcnt lgkmcnt(3)
  v_dot2c_f32_bf16_dpp v8, v100, v32 row_newbcast:0 row_mask:0xf bank_mask:0xf
  v_dot2c_f32_bf16_dpp v9, v101, v32 row_newbcast:0 row_mask:0xf bank_mask:0xf
  v_dot2c_f32_bf16_dpp v10, v100, v33 row_newbcast:0 row_mask:0xf bank_mask:0xf
  v_dot2c_f32_bf16_dpp v11, v101, v33 row_newbcast:0 row_mask:0xf bank_mask:0xf
  v_dot2c_f32_bf16_dpp v12, v100, v34 row_newbcast:0 row_mask:0xf bank_mask:0xf
  v_dot2c_f32_bf16_dpp v13, v101, v34 row_newbcast:0 row_mask:0xf bank_mask:0xf
  v_dot2c_f32_bf16_dpp v14, v100, v35 row_newbcast:0 row_mask:0xf bank_mask:0xf
  v_dot2c_f32_bf16_dpp v15, v101, v35 row_newbcast:0 row_mask:0xf bank_mask:0xf
  s_waitcnt lgkmcnt(2)
  v_dot2c_f32_bf16_dpp v8, v100, v36 row_newbcast:8 row_mask:0xf bank_mask:0xf
  v_dot2c_f32_bf16_dpp v9, v101, v36 row_newbcast:8 row_mask:0xf bank_mask:0xf
  v_dot2c_f32_bf16_dpp v10, v100, v37 row_newbcast:8 row_mask:0xf bank_mask:0xf
  v_dot2c_f32_bf16_dpp v11, v101, v37 row_newbcast:8 row_mask:0xf bank_mask:0xf
  v_dot2c_f32_bf16_dpp v12, v100, v38 row_newbcast:8 row_mask:0xf bank_mask:0xf
  v_dot2c_f32_bf16_dpp v13, v101, v38 row_newbcast:8 row_mask:0xf bank_mask:0xf
  v_dot2c_f32_bf16_dpp v14, v100, v39 row_newbcast:8 row_mask:0xf bank_mask:0xf
  v_dot2c_f32_bf16_dpp v15, v101, v39 row_newbcast:8 row_mask:0xf bank_mask:0xf
  s_waitcnt lgkmcnt(1)
  v_dot2c_f32_bf16_dpp v8, v100, v40 row_newbcast:4 row_mask:0xf bank_mask:0xf
  v_dot2c_f32_bf16_dpp v9, v101, v40 row_newbcast:4 row_mask:0xf bank_mask:0xf
  v_dot2c_f32_bf16_dpp v10, v100, v41 row_newbcast:4 row_mask:0xf bank_mask:0xf
  v_dot2c_f32_bf16_dpp v11, v101, v41 row_newbcast:4 row_mask:0xf bank_mask:0xf
  v_dot2c_f32_bf16_dpp v12, v100, v42 row_newbcast:4 row_mask:0xf bank_mask:0xf
  v_dot2c_f32_bf16_dpp v13, v101, v42 row_newbcast:4 row_mask:0xf bank_mask:0xf
  v_dot2c_f32_bf16_dpp v14, v100, v43 row_newbcast:4 row_mask:0xf bank_mask:0xf
  v_dot2c_f32_bf16_dpp v15, v101, v43 row_newbcast:4 row_mask:0xf bank_mask:0xf
  s_waitcnt lgkmcnt(0)
  v_dot2c_f32_bf16_dpp v8, v100, v44 row_newbcast:12 row_mask:0xf bank_mask:0xf
  v_dot2c_f32_bf16_dpp v9, v101, v44 row_newbcast:12 row_mask:0xf bank_mask:0xf
  v_dot2c_f32_bf16_dpp v10, v100, v45 row_newbcast:12 row_mask:0xf bank_mask:0xf
  v_dot2c_f32_bf16_dpp v11, v101, v45 row_newbcast:12 row_mask:0xf bank_mask:0xf
  v_dot2c_f32_bf16_dpp v12, v100, v46 row_newbcast:12 row_mask:0xf bank_mask:0xf
  v_dot2c_f32_bf16_dpp v13, v101, v46 row_newbcast:12 row_mask:0xf bank_mask:0xf
  v_dot2c_f32_bf16_dpp v14, v100, v47 row_newbcast:12 row_mask:0xf bank_mask:0xf
  v_dot2c_f32_bf16_dpp v15, v101, v47 row_newbcast:12 row_mask:0xf bank_mask:0xf
L_c_q3:
  ds_read_b32 v30, v19
  s_waitcnt lgkmcnt(0)
  v_readfirstlane_b32 s57, v30
  s_cmp_gt_u32 s57, 255
  s_cbranch_scc1 L_c_qg3
  s_sub_u32 s98, s98, 1
  s_cbranch_scc1 L_end
  s_branch L_c_q3
L_c_qg3:
  ds_read_b128 v[32:35], v29 offset:49152
  ds_read_b128 v[36:39], v29 offset:50176
  ds_read_b128 v[40:43], v29 offset:51200
  ds_read_b128 v[44:47], v29 offset:52224
  s_waitcnt lgkmcnt(3)
  v_dot2c_f32_bf16_dpp v8, v102, v32 row_newbcast:0 row_mask:0xf bank_mask:0xf
  v_dot2c_f32_bf16_dpp v9, v103, v32 row_newbcast:0 row_mask:0xf bank_mask:0xf
  v_dot2c_f32_bf16_dpp v10, v102, v33 row_newbcast:0 row_mask:0xf bank_mask:0xf
  v_dot2c_f32_bf16_dpp v11, v103, v33 row_newbcast:0 row_mask:0xf bank_mask:0xf
  v_dot2c_f32_bf16_dpp v12, v102, v34 row_newbcast:0 row_mask:0xf bank_mask:0xf
  v_dot2c_f32_bf16_dpp v13, v103, v34 row_newbcast:0 row_mask:0xf bank_mask:0xf
  v_dot2c_f32_bf16_dpp v14, v102, v35 row_newbcast:0 row_mask:0xf bank_mask:0xf
  v_dot2c_f32_bf16_dpp v15, v103, v35 row_newbcast:0 row_mask:0xf bank_mask:0xf
  s_waitcnt lgkmcnt(2)
  v_dot2c_f32_bf16_dpp v8, v102, v36 row_newbcast:8 row_mask:0xf bank_mask:0xf
  v_dot2c_f32_bf16_dpp v9, v103, v36 row_newbcast:8 row_mask:0xf bank_mask:0xf
  v_dot2c_f32_bf16_dpp v10, v102, v37 row_newbcast:8 row_mask:0xf bank_mask:0xf
  v_dot2c_f32_bf16_dpp v11, v103, v37 row_newbcast:8 row_mask:0xf bank_mask:0xf
  v_dot2c_f32_bf16_dpp v12, v102, v38 row_newbcast:8 row_mask:0xf bank_mask:0xf
  v_dot2c_f32_bf16_dpp v13, v103, v38 row_newbcast:8 row_mask:0xf bank_mask:0xf
  v_dot2c_f32_bf16_dpp v14, v102, v39 row_newbcast:8 row_mask:0xf bank_mask:0xf
  v_dot2c_f32_bf16_dpp v15, v103, v39 row_newbcast:8 row_mask:0xf bank_mask:0xf
  s_waitcnt lgkmcnt(1)
  v_dot2c_f32_bf16_dpp v8, v102, v40 row_newbcast:4 row_mask:0xf bank_mask:0xf
  v_dot2c_f32_bf16_dpp v9, v103, v40 row_newbcast:4 row_mask:0xf bank_mask:0xf
  v_dot2c_f32_bf16_dpp v10, v102, v41 row_newbcast:4 row_mask:0xf bank_mask:0xf
  v_dot2c_f32_bf16_dpp v11, v103, v41 row_newbcast:4 row_mask:0xf bank_mask:0xf
  v_dot2c_f32_bf16_dpp v12, v102, v42 row_newbcast:4 row_mask:0xf bank_mask:0xf
  v_dot2c_f32_bf16_dpp v13, v103, v42 row_newbcast:4 row_mask:0xf bank_mask:0xf
  v_dot2c_f32_bf16_dpp v14, v102, v43 row_newbcast:4 row_mask:0xf bank_mask:0xf
  v_dot2c_f32_bf16_dpp v15, v103, v43 row_newbcast:4 row_mask:0xf bank_mask:0xf
  s_waitcnt lgkmcnt(0)
  v_dot2c_f32_bf16_dpp v8, v102, v44 row_newbcast:12 row_mask:0xf bank_mask:0xf
  v_dot2c_f32_bf16_dpp v9, v103, v44 row_newbcast:12 row_mask:0xf bank_mask:0xf
  v_dot2c_f32_bf16_dpp v10, v102, v45 row_newbcast:12 row_mask:0xf bank_mask:0xf
  v_dot2c_f32_bf16_dpp v11, v103, v45 row_newbcast:12 row_mask:0xf bank_mask:0xf
  v_dot2c_f32_bf16_dpp v12, v102, v46 row_newbcast:12 row_mask:0xf bank_mask:0xf
  v_dot2c_f32_bf16_dpp v13, v103, v46 row_newbcast:12 row_mask:0xf bank_mask:0xf
  v_dot2c_f32_bf16_dpp v14, v102, v47 row_newbcast:12 row_mask:0xf bank_mask:0xf
  v_dot2c_f32_bf16_dpp v15, v103, v47 row_newbcast:12 row_mask:0xf bank_mask:0xf
  v_and_b32 v28, 7, v0
  v_lshlrev_b32 v29, 12, v28
  v_lshrrev_b32 v27, 3, v0
  v_lshl_add_u32 v29, v27, 4, v29
  ds_write_b128 v176, v[8:11]
  ds_write_b128 v176, v[12:15] offset:16
  v_lshlrev_b32 v20, 2, v27
  v_add_u32 v20, 153600, v20
  ds_read_b32 v178, v20
  v_mov_b32 v20, 131136
  ds_read_b32 v182, v20 offset:16
  ds_read_b128 v[184:187], v20
  v_and_b32 v22, 31, v0
  v_lshlrev_b32 v22, 2, v22
  v_add_u32 v22, 153664, v22
  ds_read_b32 v183, v22
  v_lshlrev_b32 v21, 10, v27
  v_lshl_add_u32 v21, v28, 5, v21
  s_lshl_b32 s56, s4, 13
  s_lshl_b32 s57, s6, 8
  s_add_u32 s56, s56, s57
  s_add_u32 s58, s56, 589824
  s_add_u32 s56, s56, 327680
  s_mov_b32 s59, 0
  s_mov_b32 s76, 0
  s_waitcnt lgkmcnt(0)
  s_barrier
  s_cmp_lg_u32 s6, 0
  s_cbranch_scc1 L_e_poll1
  ds_read_b64 v[32:33], v177 offset:0
  ds_read_b64 v[34:35], v177 offset:512
  ds_read_b64 v[36:37], v177 offset:1024
  ds_read_b64 v[38:39], v177 offset:1536
  ds_read_b64 v[40:41], v177 offset:2048
  ds_read_b64 v[42:43], v177 offset:2560
  ds_read_b64 v[44:45], v177 offset:3072
  ds_read_b64 v[46:47], v177 offset:3584
  ds_read_b64 v[48:49], v177 offset:4096
  ds_read_b64 v[50:51], v177 offset:4608
  ds_read_b64 v[52:53], v177 offset:5120
  ds_read_b64 v[54:55], v177 offset:5632
  ds_read_b64 v[56:57], v177 offset:6144
  ds_read_b64 v[58:59], v177 offset:6656
  ds_read_b64 v[60:61], v177 offset:7168
  ds_read_b64 v[62:63], v177 offset:7680
  v_mov_b32 v65, v182
  v_mov_b32 v67, v182
  s_waitcnt lgkmcnt(0)
  v_add_f32 v32, v32, v48
  v_add_f32 v33, v33, v49
  v_add_f32 v34, v34, v50
  v_add_f32 v35, v35, v51
  v_add_f32 v36, v36, v52
  v_add_f32 v37, v37, v53
  v_add_f32 v38, v38, v54
  v_add_f32 v39, v39, v55
  v_add_f32 v40, v40, v56
  v_add_f32 v41, v41, v57
  v_add_f32 v42, v42, v58
  v_add_f32 v43, v43, v59
  v_add_f32 v44, v44, v60
  v_add_f32 v45, v45, v61
  v_add_f32 v46, v46, v62
  v_add_f32 v47, v47, v63
  v_add_f32 v32, v32, v40
  v_add_f32 v33, v33, v41
  v_add_f32 v34, v34, v42
  v_add_f32 v35, v35, v43
  v_add_f32 v36, v36, v44
  v_add_f32 v37, v37, v45
  v_add_f32 v38, v38, v46
  v_add_f32 v39, v39, v47
  v_add_f32 v32, v32, v36
  v_add_f32 v33, v33, v37
  v_add_f32 v34, v34, v38
  v_add_f32 v35, v35, v39
  v_add_f32 v64, v32, v34
  v_add_f32 v66, v33, v35
  s_add_u32 s57, s80, 262144
  buffer_store_dwordx4 v[64:67], v2, s[44:47], s57 offen
  s_mov_b32 s76, 1
L_e_poll1:
  s_add_u32 s59, s59, 1
  s_and_b32 s57, s59, 15
  s_cbranch_scc0 L_e_poll1s
  buffer_load_dwordx4 v[32:35], v21, s[44:47], s58 offen nt
  buffer_load_dwordx4 v[36:39], v21, s[44:47], s58 offen offset:16 nt
  s_branch L_e_poll1w
L_e_poll1s:
  s_cmp_eq_u32 s76, 0
  s_cbranch_scc1 L_e_own1
  s_mov_b64 s[78:79], exec
  s_mov_b64 exec, -1
  buffer_store_dwordx4 v[64:67], v2, s[44:47], s80 offen sc0 sc1
  s_mov_b64 exec, s[78:79]
  s_mov_b32 s76, 0
L_e_own1:
  buffer_load_dwordx4 v[32:35], v21, s[44:47], s56 offen sc0 sc1
  buffer_load_dwordx4 v[36:39], v21, s[44:47], s56 offen offset:16 sc0 sc1
L_e_poll1w:
  s_waitcnt vmcnt(0)
  v_xor_b32 v22, v33, v178
  v_xor_b32 v23, v35, v178
  v_xor_b32 v24, v37, v178
  v_xor_b32 v25, v39, v178
  v_or_b32 v22, v22, v23
  v_or3_b32 v22, v24, v25, v22
  v_cmp_ne_u32 vcc, 0, v22
  s_cbranch_vccz L_e_got1
  s_mov_b64 exec, vcc
  s_sub_u32 s98, s98, 1
  s_cbranch_scc1 L_end
  s_branch L_e_poll1
L_e_got1:
  s_mov_b64 exec, -1
  ds_read_b32 v30, v19
  s_lshl_b32 s57, s6, 12
  v_add_u32 v29, s57, v2
  v_add_f32_dpp v32, v32, v32 row_ror:8 row_mask:0xf bank_mask:0xf
  v_add_f32_dpp v34, v34, v34 row_ror:8 row_mask:0xf bank_mask:0xf
  v_add_f32_dpp v36, v36, v36 row_ror:8 row_mask:0xf bank_mask:0xf
  v_add_f32_dpp v38, v38, v38 row_ror:8 row_mask:0xf bank_mask:0xf
L_e_wo:
  s_waitcnt lgkmcnt(0)
  v_readfirstlane_b32 s57, v30
  s_cmp_gt_u32 s57, 256
  s_cbranch_scc1 L_e_wo2
  s_sub_u32 s98, s98, 1
  s_cbranch_scc1 L_end
  ds_read_b32 v30, v19
  s_branch L_e_wo
L_e_wo2:
  ds_read_b128 v[160:163], v29 offset:0
  ds_read_b128 v[164:167], v29 offset:1024
  ds_read_b128 v[168:171], v29 offset:2048
  ds_read_b128 v[172:175], v29 offset:3072
  v_mov_b32 v33, v32
  v_mov_b32 v35, v34
  v_mov_b32 v37, v36
  v_mov_b32 v39, v38
  s_nop 0
  v_permlane16_swap_b32 v32, v33
  v_permlane16_swap_b32 v34, v35
  v_permlane16_swap_b32 v36, v37
  v_permlane16_swap_b32 v38, v39
  v_add_f32 v32, v32, v33
  v_add_f32 v34, v34, v35
  v_add_f32 v36, v36, v37
  v_add_f32 v38, v38, v39
  v_mov_b32 v33, v32
  v_mov_b32 v35, v34
  v_mov_b32 v37, v36
  v_mov_b32 v39, v38
  s_nop 0
  v_permlane32_swap_b32 v32, v33
  v_permlane32_swap_b32 v34, v35
  v_permlane32_swap_b32 v36, v37
  v_permlane32_swap_b32 v38, v39
  v_add_f32 v32, v32, v33
  v_add_f32 v34, v34, v35
  v_add_f32 v36, v36, v37
  v_add_f32 v38, v38, v39
  v_mov_b32 v8, 0
  v_mov_b32 v9, 0
  v_mov_b32 v10, 0
  v_mov_b32 v11, 0
  v_mov_b32 v12, 0
  v_mov_b32 v13, 0
  v_mov_b32 v14, 0
  v_mov_b32 v15, 0
  v_cvt_pk_bf16_f32 v40, v32, 0
  v_cvt_pk_bf16_f32 v44, 0, v32
  v_cvt_pk_bf16_f32 v41, v34, 0
  v_cvt_pk_bf16_f32 v45, 0, v34
  v_cvt_pk_bf16_f32 v42, v36, 0
  v_cvt_pk_bf16_f32 v46, 0, v36
  v_cvt_pk_bf16_f32 v43, v38, 0
  v_cvt_pk_bf16_f32 v47, 0, v38
  s_waitcnt lgkmcnt(0)
  v_dot2c_f32_bf16 v8, v40, v160
  v_dot2c_f32_bf16 v9, v44, v160
  v_dot2c_f32_bf16 v10, v40, v161
  v_dot2c_f32_bf16 v11, v44, v161
  v_dot2c_f32_bf16 v12, v40, v162
  v_dot2c_f32_bf16 v13, v44, v162
  v_dot2c_f32_bf16 v14, v40, v163
  v_dot2c_f32_bf16 v15, v44, v163
  v_dot2c_f32_bf16 v8, v41, v164
  v_dot2c_f32_bf16 v9, v45, v164
  v_dot2c_f32_bf16 v10, v41, v165
  v_dot2c_f32_bf16 v11, v45, v165
  v_dot2c_f32_bf16 v12, v41, v166
  v_dot2c_f32_bf16 v13, v45, v166
  v_dot2c_f32_bf16 v14, v41, v167
  v_dot2c_f32_bf16 v15, v45, v167
  v_dot2c_f32_bf16 v8, v42, v168
  v_dot2c_f32_bf16 v9, v46, v168
  v_dot2c_f32_bf16 v10, v42, v169
  v_dot2c_f32_bf16 v11, v46, v169
  v_dot2c_f32_bf16 v12, v42, v170
  v_dot2c_f32_bf16 v13, v46, v170
  v_dot2c_f32_bf16 v14, v42, v171
  v_dot2c_f32_bf16 v15, v46, v171
  v_dot2c_f32_bf16 v8, v43, v172
  v_dot2c_f32_bf16 v9, v47, v172
  v_dot2c_f32_bf16 v10, v43, v173
  v_dot2c_f32_bf16 v11, v47, v173
  v_dot2c_f32_bf16 v12, v43, v174
  v_dot2c_f32_bf16 v13, v47, v174
  v_dot2c_f32_bf16 v14, v43, v175
  v_dot2c_f32_bf16 v15, v47, v175
  v_lshlrev_b32 v20, 5, v27
  s_lshl_b32 s57, s6, 8
  s_add_u32 s57, s57, 153856
  v_add_u32 v20, s57, v20
  v_add_f32_dpp v8, v8, v8 quad_perm:[1,0,3,2] row_mask:0xf bank_mask:0xf
  v_add_f32_dpp v9, v9, v9 quad_perm:[1,0,3,2] row_mask:0xf bank_mask:0xf
  v_add_f32_dpp v10, v10, v10 quad_perm:[1,0,3,2] row_mask:0xf bank_mask:0xf
  v_add_f32_dpp v11, v11, v11 quad_perm:[1,0,3,2] row_mask:0xf bank_mask:0xf
  v_add_f32_dpp v12, v12, v12 quad_perm:[1,0,3,2] row_mask:0xf bank_mask:0xf
  v_add_f32_dpp v13, v13, v13 quad_perm:[1,0,3,2] row_mask:0xf bank_mask:0xf
  v_add_f32_dpp v14, v14, v14 quad_perm:[1,0,3,2] row_mask:0xf bank_mask:0xf
  v_add_f32_dpp v15, v15, v15 quad_perm:[1,0,3,2] row_mask:0xf bank_mask:0xf
  v_add_f32_dpp v8, v8, v8 quad_perm:[2,3,0,1] row_mask:0xf bank_mask:0xf
  v_add_f32_dpp v9, v9, v9 quad_perm:[2,3,0,1] row_mask:0xf bank_mask:0xf
  v_add_f32_dpp v10, v10, v10 quad_perm:[2,3,0,1] row_mask:0xf bank_mask:0xf
  v_add_f32_dpp v11, v11, v11 quad_perm:[2,3,0,1] row_mask:0xf bank_mask:0xf
  v_add_f32_dpp v12, v12, v12 quad_perm:[2,3,0,1] row_mask:0xf bank_mask:0xf
  v_add_f32_dpp v13, v13, v13 quad_perm:[2,3,0,1] row_mask:0xf bank_mask:0xf
  v_add_f32_dpp v14, v14, v14 quad_perm:[2,3,0,1] row_mask:0xf bank_mask:0xf
  v_add_f32_dpp v15, v15, v15 quad_perm:[2,3,0,1] row_mask:0xf bank_mask:0xf
  v_add_f32_dpp v8, v8, v8 row_half_mirror row_mask:0xf bank_mask:0xf
  v_add_f32_dpp v9, v9, v9 row_half_mirror row_mask:0xf bank_mask:0xf
  v_add_f32_dpp v10, v10, v10 row_half_mirror row_mask:0xf bank_mask:0xf
  v_add_f32_dpp v11, v11, v11 row_half_mirror row_mask:0xf bank_mask:0xf
  v_add_f32_dpp v12, v12, v12 row_half_mirror row_mask:0xf bank_mask:0xf
  v_add_f32_dpp v13, v13, v13 row_half_mirror row_mask:0xf bank_mask:0xf
  v_add_f32_dpp v14, v14, v14 row_half_mirror row_mask:0xf bank_mask:0xf
  v_add_f32_dpp v15, v15, v15 row_half_mirror row_mask:0xf bank_mask:0xf
  s_mov_b32 s58, 0x01010101
  s_mov_b32 s59, 0x01010101
  s_mov_b64 exec, s[58:59]
  ds_write_b128 v20, v[8:11]
  ds_write_b128 v20, v[12:15] offset:16
  s_mov_b64 exec, -1
  v_lshlrev_b32 v20, 2, v0
  v_add_u32 v21, 153856, v20
  s_waitcnt lgkmcnt(0)
  s_barrier
  s_cmp_lg_u32 s6, 0
  s_cbranch_scc1 L_end
  ds_read_b32 v32, v21 offset:0
  ds_read_b32 v33, v21 offset:256
  ds_read_b32 v34, v21 offset:512
  ds_read_b32 v35, v21 offset:768
  v_add_u32 v22, 153344, v20
  ds_read_b32 v70, v22
  v_mov_b32 v69, v182
  v_mov_b32 v71, v182
  s_mov_b32 s59, 0
  v_and_b32 v22, 31, v0
  v_lshlrev_b32 v22, 13, v22
  v_lshrrev_b32 v23, 5, v0
  v_lshl_add_u32 v22, v23, 4, v22
  s_lshl_b32 s56, s5, 10
  s_lshl_b32 s57, s4, 5
  s_add_u32 s56, s56, s57
  s_add_u32 s56, s56, 65536
  s_waitcnt lgkmcnt(0)
  v_add_f32 v32, v32, v33
  v_add_f32 v34, v34, v35
  v_add_f32 v68, v32, v34
  buffer_store_dwordx4 v[68:71], v2, s[44:47], s82 offen sc0 sc1
L_e_poll2:
  buffer_load_dwordx4 v[8:11], v22, s[44:47], s56 offen sc0 sc1
  s_waitcnt vmcnt(0)
  v_xor_b32 v12, v9, v183
  v_xor_b32 v13, v11, v183
  v_or_b32 v12, v12, v13
  v_cmp_ne_u32 vcc, 0, v12
  s_cbranch_vccz L_e_got2
  s_mov_b64 exec, vcc
  s_sub_u32 s98, s98, 1
  s_cbranch_scc1 L_end
  s_add_u32 s59, s59, 1
  s_cmp_lt_u32 s59, 4
  s_cbranch_scc1 L_e_poll2
  s_cmp_eq_u32 s76, 0
  s_cbranch_scc1 L_e_own3
  s_mov_b64 s[78:79], exec
  s_mov_b64 exec, -1
  buffer_store_dwordx4 v[64:67], v2, s[44:47], s80 offen sc0 sc1
  s_mov_b64 exec, s[78:79]
  s_mov_b32 s76, 0
L_e_own3:
  s_branch L_e_poll2
L_e_got2:
  s_mov_b64 exec, -1
  s_nop 0
  v_add_f32_dpp v8, v8, v8 row_ror:1 row_mask:0xf bank_mask:0xf
  v_add_f32_dpp v10, v10, v10 row_ror:1 row_mask:0xf bank_mask:0xf
  s_nop 0
  v_add_f32_dpp v8, v8, v8 row_ror:2 row_mask:0xf bank_mask:0xf
  v_add_f32_dpp v10, v10, v10 row_ror:2 row_mask:0xf bank_mask:0xf
  s_nop 0
  v_add_f32_dpp v8, v8, v8 row_ror:4 row_mask:0xf bank_mask:0xf
  v_add_f32_dpp v10, v10, v10 row_ror:4 row_mask:0xf bank_mask:0xf
  s_nop 0
  v_add_f32_dpp v8, v8, v8 row_ror:8 row_mask:0xf bank_mask:0xf
  v_add_f32_dpp v10, v10, v10 row_ror:8 row_mask:0xf bank_mask:0xf
  s_nop 0
  v_readlane_b32 s60, v8, 0
  v_readlane_b32 s61, v8, 16
  v_readlane_b32 s62, v8, 32
  v_readlane_b32 s63, v8, 48
  v_readlane_b32 s64, v10, 0
  v_readlane_b32 s65, v10, 16
  v_readlane_b32 s66, v10, 32
  v_readlane_b32 s67, v10, 48
  s_nop 0
  v_mov_b32 v8, s60
  v_mov_b32 v9, s62
  v_mov_b32 v10, s64
  v_mov_b32 v11, s66
  v_add_f32 v8, s61, v8
  v_add_f32 v9, s63, v9
  v_add_f32 v10, s65, v10
  v_add_f32 v11, s67, v11
  v_cvt_pk_bf16_f32 v8, 0, v8
  v_cvt_pk_bf16_f32 v9, 0, v9
  v_cvt_pk_bf16_f32 v10, 0, v10
  v_cvt_pk_bf16_f32 v11, 0, v11
  v_add_f32 v8, v184, v8
  v_add_f32 v9, v185, v9
  v_add_f32 v10, v186, v10
  v_add_f32 v11, v187, v11
  v_cvt_pk_bf16_f32 v8, 0, v8
  v_cvt_pk_bf16_f32 v9, 0, v9
  v_cvt_pk_bf16_f32 v10, 0, v10
  v_cvt_pk_bf16_f32 v11, 0, v11
  v_add_f32 v8, v8, v10
  v_add_f32 v9, v9, v11
  v_cvt_pk_bf16_f32 v8, v8, v9
  s_lshl_b32 s56, s5, 7
  s_lshl_b32 s57, s4, 2
  s_add_u32 s56, s56, s57
  v_mov_b32 v9, 0
  s_mov_b64 exec, 1
  buffer_store_dword v8, v9, s[52:55], s56 offen
  s_cmp_eq_u32 s76, 0
  s_cbranch_scc1 L_e_own4
  s_mov_b64 s[78:79], exec
  s_mov_b64 exec, -1
  buffer_store_dwordx4 v[64:67], v2, s[44:47], s80 offen sc0 sc1
  s_mov_b64 exec, s[78:79]
  s_mov_b32 s76, 0
L_e_own4:
  s_mov_b64 exec, -1
  s_endpgm
L_helper:
  v_lshlrev_b32 v3, 2, v0
  v_add_u32 v4, 131072, v3
  v_mov_b32 v5, 0
  ds_write_b32 v4, v5
  s_waitcnt lgkmcnt(0)
  s_barrier
  v_mov_b32 v8, -1
  v_mov_b32 v9, -1
  v_mov_b32 v10, -1
  v_mov_b32 v11, -1
  s_mov_b32 s44, s40
  s_mov_b32 s45, s41
  s_mov_b32 s46, 983040
  s_mov_b32 s47, 0x20000
  s_mov_b32 s8, s16
  s_mov_b32 s9, s17
  s_mov_b32 s10, 1024
  s_mov_b32 s11, 0x20000
  s_mov_b32 s12, s28
  s_mov_b32 s13, s29
  s_mov_b32 s14, 1835008
  s_mov_b32 s15, 0x20000
  s_cmp_lt_u32 s4, 28
  s_cselect_b32 s14, s14, 0
  s_mov_b32 s48, s32
  s_mov_b32 s49, s33
  s_mov_b32 s50, 1835008
  s_mov_b32 s51, 0x20000
  s_mov_b32 s52, s30
  s_mov_b32 s53, s31
  s_mov_b32 s54, 3584
  s_mov_b32 s55, 0x20000
  s_mov_b32 s64, s34
  s_mov_b32 s65, s35
  s_mov_b32 s66, 1024
  s_mov_b32 s67, 0x20000
  s_mov_b32 s68, s38
  s_mov_b32 s69, s39
  s_mov_b32 s70, 256
  s_mov_b32 s71, 0x20000
  s_lshl_b32 s82, s7, 10
  s_add_u32 s80, s82, 327680
  s_add_u32 s82, s82, 65536
  v_mov_b32 v191, 131072
L_wl_h0:
  s_sub_u32 s98, s98, 1
  s_cbranch_scc1 L_end
  s_sleep 8
  ds_read_b32 v1, v191
  s_waitcnt lgkmcnt(0)
  v_readfirstlane_b32 s75, v1
  s_cmp_ge_u32 s75, 10
  s_cbranch_scc0 L_wl_h0
  s_cmp_lg_u32 s2, 0
  s_cbranch_scc1 L_h_noclear
  s_mov_b32 s57, 0
  buffer_store_dwordx4 v[8:11], v2, s[44:47], s57 offen offset:0 sc0 sc1
  buffer_store_dwordx4 v[8:11], v2, s[44:47], s57 offen offset:1024 sc0 sc1
  buffer_store_dwordx4 v[8:11], v2, s[44:47], s57 offen offset:2048 sc0 sc1
  buffer_store_dwordx4 v[8:11], v2, s[44:47], s57 offen offset:3072 sc0 sc1
  s_add_u32 s57, s57, 4096
  buffer_store_dwordx4 v[8:11], v2, s[44:47], s57 offen offset:0 sc0 sc1
  buffer_store_dwordx4 v[8:11], v2, s[44:47], s57 offen offset:1024 sc0 sc1
  buffer_store_dwordx4 v[8:11], v2, s[44:47], s57 offen offset:2048 sc0 sc1
  buffer_store_dwordx4 v[8:11], v2, s[44:47], s57 offen offset:3072 sc0 sc1
  s_add_u32 s57, s57, 4096
  buffer_store_dwordx4 v[8:11], v2, s[44:47], s57 offen offset:0 sc0 sc1
  buffer_store_dwordx4 v[8:11], v2, s[44:47], s57 offen offset:1024 sc0 sc1
  buffer_store_dwordx4 v[8:11], v2, s[44:47], s57 offen offset:2048 sc0 sc1
  buffer_store_dwordx4 v[8:11], v2, s[44:47], s57 offen offset:3072 sc0 sc1
  s_add_u32 s57, s57, 4096
  buffer_store_dwordx4 v[8:11], v2, s[44:47], s57 offen offset:0 sc0 sc1
  buffer_store_dwordx4 v[8:11], v2, s[44:47], s57 offen offset:1024 sc0 sc1
  buffer_store_dwordx4 v[8:11], v2, s[44:47], s57 offen offset:2048 sc0 sc1
  buffer_store_dwordx4 v[8:11], v2, s[44:47], s57 offen offset:3072 sc0 sc1
  s_add_u32 s57, s57, 4096
  buffer_store_dwordx4 v[8:11], v2, s[44:47], s57 offen offset:0 sc0 sc1
  buffer_store_dwordx4 v[8:11], v2, s[44:47], s57 offen offset:1024 sc0 sc1
  buffer_store_dwordx4 v[8:11], v2, s[44:47], s57 offen offset:2048 sc0 sc1
  buffer_store_dwordx4 v[8:11], v2, s[44:47], s57 offen offset:3072 sc0 sc1
  s_add_u32 s57, s57, 4096
  buffer_store_dwordx4 v[8:11], v2, s[44:47], s57 offen offset:0 sc0 sc1
  buffer_store_dwordx4 v[8:11], v2, s[44:47], s57 offen offset:1024 sc0 sc1
  buffer_store_dwordx4 v[8:11], v2, s[44:47], s57 offen offset:2048 sc0 sc1
  buffer_store_dwordx4 v[8:11], v2, s[44:47], s57 offen offset:3072 sc0 sc1
  s_add_u32 s57, s57, 4096
  buffer_store_dwordx4 v[8:11], v2, s[44:47], s57 offen offset:0 sc0 sc1
  buffer_store_dwordx4 v[8:11], v2, s[44:47], s57 offen offset:1024 sc0 sc1
  buffer_store_dwordx4 v[8:11], v2, s[44:47], s57 offen offset:2048 sc0 sc1
  buffer_store_dwordx4 v[8:11], v2, s[44:47], s57 offen offset:3072 sc0 sc1
  s_add_u32 s57, s57, 4096
  buffer_store_dwordx4 v[8:11], v2, s[44:47], s57 offen offset:0 sc0 sc1
  buffer_store_dwordx4 v[8:11], v2, s[44:47], s57 offen offset:1024 sc0 sc1
  buffer_store_dwordx4 v[8:11], v2, s[44:47], s57 offen offset:2048 sc0 sc1
  buffer_store_dwordx4 v[8:11], v2, s[44:47], s57 offen offset:3072 sc0 sc1
  s_add_u32 s57, s57, 4096
  s_waitcnt vmcnt(0)
  v_mov_b32 v5, 0
  v_mov_b32 v6, 1
  s_mov_b64 exec, 1
  buffer_store_dword v6, v5, s[68:71], 0 offen sc0 sc1
  s_mov_b64 exec, -1
L_h_noclear:
  v_mov_b32 v5, 0
  buffer_load_dwordx4 v[96:99], v2, s[44:47], s80 offen sc0 sc1 nt
  buffer_load_dwordx4 v[100:103], v2, s[44:47], s82 offen sc0 sc1 nt
  s_add_u32 s57, s80, 262144
  buffer_load_dwordx4 v[108:111], v2, s[44:47], s57 offen sc0 sc1 nt
  s_and_b32 s88, s2, 7
  s_lshl_b32 s88, s88, 9
  s_add_u32 s88, s88, 32768
  s_lshr_b32 s89, s2, 3
  s_lshl_b32 s89, s89, 3
  s_add_u32 s89, s89, s88
  buffer_load_dwordx2 v[104:105], v5, s[44:47], s89 offen sc0 sc1 nt
  buffer_load_dwordx2 v[106:107], v5, s[44:47], s89 offen offset:256 sc0 sc1 nt
  s_lshl_b32 s99, s7, 4
  s_add_u32 s99, s99, 36864
  buffer_load_dwordx4 v[112:115], v5, s[44:47], s99 offen sc0 sc1 nt
  s_lshl_b32 s58, s7, 9
  s_add_u32 s58, s58, 851968
  v_lshlrev_b32 v187, 3, v0
  buffer_load_dwordx2 v[116:117], v187, s[44:47], s58 offen sc0 sc1 nt
  buffer_load_dwordx4 v[28:31], v2, s[8:11], 0 offen nt
  v_lshlrev_b32 v7, 1, v0
  s_mul_i32 s72, s4, 128
  buffer_load_ushort v188, v7, s[52:55], s72 offen nt
  s_lshl_b32 s72, s5, 7
  s_lshl_b32 s73, s4, 2
  s_add_u32 s72, s72, s73
  buffer_load_dword v189, v5, s[8:11], s72 offen nt
  buffer_load_dword v190, v5, s[64:67], s72 offen nt
  v_lshrrev_b32 v4, 3, v0
  v_and_b32 v5, 7, v0
  v_mul_u32_u24 v6, 3584, v4
  v_lshlrev_b32 v7, 4, v5
  v_add_u32 v6, v6, v7
  v_lshlrev_b32 v7, 10, v4
  v_lshl_add_u32 v7, v5, 4, v7
  s_mul_i32 s59, s4, 128
  s_mul_i32 s76, s5, 229376
  s_add_u32 s59, s59, s76
  s_mul_i32 s76, s4, 65536
  s_lshl_b32 s73, s5, 7
  s_add_u32 s76, s76, s73
  s_mov_b32 s74, 147968
  s_waitcnt vmcnt(0)
  v_readfirstlane_b32 s84, v97
L_h_ep:
  s_add_u32 s84, s84, 1
  s_cmp_eq_u32 s84, -1
  s_cbranch_scc1 L_h_ep
  s_mov_b64 s[86:87], 0
  v_cmp_eq_u32 vcc, s84, v97
  s_or_b64 s[86:87], s[86:87], vcc
  v_cmp_eq_u32 vcc, s84, v99
  s_or_b64 s[86:87], s[86:87], vcc
  v_cmp_eq_u32 vcc, s84, v101
  s_or_b64 s[86:87], s[86:87], vcc
  v_cmp_eq_u32 vcc, s84, v103
  s_or_b64 s[86:87], s[86:87], vcc
  v_cmp_eq_u32 vcc, s84, v105
  s_or_b64 s[86:87], s[86:87], vcc
  v_cmp_eq_u32 vcc, s84, v107
  s_or_b64 s[86:87], s[86:87], vcc
  v_cmp_eq_u32 vcc, s84, v109
  s_or_b64 s[86:87], s[86:87], vcc
  v_cmp_eq_u32 vcc, s84, v111
  s_or_b64 s[86:87], s[86:87], vcc
  v_cmp_eq_u32 vcc, s84, v113
  s_or_b64 s[86:87], s[86:87], vcc
  v_cmp_eq_u32 vcc, s84, v115
  s_or_b64 s[86:87], s[86:87], vcc
  v_cmp_eq_u32 vcc, s84, v117
  s_or_b64 s[86:87], s[86:87], vcc
  s_cmp_lg_u64 s[86:87], 0
  s_cbranch_scc1 L_h_ep
  buffer_load_dwordx4 v[32:35], v6, s[12:15], s59 offen nt
  s_add_u32 s59, s59, 28672
  buffer_load_dwordx4 v[36:39], v6, s[12:15], s59 offen nt
  s_add_u32 s59, s59, 28672
  buffer_load_dwordx4 v[40:43], v6, s[12:15], s59 offen nt
  s_add_u32 s59, s59, 28672
  buffer_load_dwordx4 v[44:47], v6, s[12:15], s59 offen nt
  s_add_u32 s59, s59, 28672
  buffer_load_dwordx4 v[48:51], v6, s[12:15], s59 offen nt
  s_add_u32 s59, s59, 28672
  buffer_load_dwordx4 v[52:55], v6, s[12:15], s59 offen nt
  s_add_u32 s59, s59, 28672
  buffer_load_dwordx4 v[56:59], v6, s[12:15], s59 offen nt
  s_add_u32 s59, s59, 28672
  buffer_load_dwordx4 v[60:63], v6, s[12:15], s59 offen nt
  s_add_u32 s59, s59, 28672
  v_lshlrev_b32 v8, 16, v28
  v_and_b32 v9, 0xffff0000, v28
  v_lshlrev_b32 v10, 16, v29
  v_and_b32 v11, 0xffff0000, v29
  v_lshlrev_b32 v12, 16, v30
  v_and_b32 v13, 0xffff0000, v30
  v_lshlrev_b32 v14, 16, v31
  v_and_b32 v15, 0xffff0000, v31
  v_add_f32 v16, v8, v9
  v_add_f32 v17, v10, v11
  v_add_f32 v18, v12, v13
  v_add_f32 v19, v14, v15
  v_add_f32 v16, v16, v17
  v_add_f32 v18, v18, v19
  v_add_f32 v16, v16, v18
  s_nop 1
  v_add_f32_dpp v16, v16, v16 row_ror:1 row_mask:0xf bank_mask:0xf
  s_nop 1
  v_add_f32_dpp v16, v16, v16 row_ror:2 row_mask:0xf bank_mask:0xf
  s_nop 1
  v_add_f32_dpp v16, v16, v16 row_ror:4 row_mask:0xf bank_mask:0xf
  s_nop 1
  v_add_f32_dpp v16, v16, v16 row_ror:8 row_mask:0xf bank_mask:0xf
  s_nop 0
  v_readlane_b32 s60, v16, 0
  v_readlane_b32 s61, v16, 16
  v_readlane_b32 s62, v16, 32
  v_readlane_b32 s63, v16, 48
  s_nop 1
  v_mov_b32 v16, s60
  v_mov_b32 v17, s62
  v_add_f32 v16, s61, v16
  v_add_f32 v17, s63, v17
  v_add_f32 v16, v16, v17
  v_mul_f32 v16, 0x3b000000, v16
  v_mov_b32 v18, 0
  v_sub_f32 v19, v8, v16
  v_fmac_f32 v18, v19, v19
  v_sub_f32 v19, v9, v16
  v_fmac_f32 v18, v19, v19
  v_sub_f32 v19, v10, v16
  v_fmac_f32 v18, v19, v19
  v_sub_f32 v19, v11, v16
  v_fmac_f32 v18, v19, v19
  v_sub_f32 v19, v12, v16
  v_fmac_f32 v18, v19, v19
  v_sub_f32 v19, v13, v16
  v_fmac_f32 v18, v19, v19
  v_sub_f32 v19, v14, v16
  v_fmac_f32 v18, v19, v19
  v_sub_f32 v19, v15, v16
  v_fmac_f32 v18, v19, v19
  s_nop 1
  v_add_f32_dpp v18, v18, v18 row_ror:1 row_mask:0xf bank_mask:0xf
  s_nop 1
  v_add_f32_dpp v18, v18, v18 row_ror:2 row_mask:0xf bank_mask:0xf
  s_nop 1
  v_add_f32_dpp v18, v18, v18 row_ror:4 row_mask:0xf bank_mask:0xf
  s_nop 1
  v_add_f32_dpp v18, v18, v18 row_ror:8 row_mask:0xf bank_mask:0xf
  s_nop 0
  v_readlane_b32 s60, v18, 0
  v_readlane_b32 s61, v18, 16
  v_readlane_b32 s62, v18, 32
  v_readlane_b32 s63, v18, 48
  s_nop 1
  v_mov_b32 v18, s60
  v_mov_b32 v17, s62
  v_add_f32 v18, s61, v18
  v_add_f32 v17, s63, v17
  v_add_f32 v18, v18, v17
  v_mul_f32 v18, 0x3b000000, v18
  v_cvt_pk_bf16_f32 v16, 0, v16
  v_cvt_pk_bf16_f32 v18, 0, v18
  v_add_f32 v18, 0x3727c5ac, v18
  v_cvt_pk_bf16_f32 v18, 0, v18
  v_sqrt_f32 v18, v18
  s_nop 0
  v_cvt_pk_bf16_f32 v18, 0, v18
  v_rcp_f32 v19, v18
  v_sub_f32 v8, v8, v16
  v_sub_f32 v9, v9, v16
  v_sub_f32 v10, v10, v16
  v_sub_f32 v11, v11, v16
  v_sub_f32 v12, v12, v16
  v_sub_f32 v13, v13, v16
  v_sub_f32 v14, v14, v16
  v_sub_f32 v15, v15, v16
  v_cvt_pk_bf16_f32 v8, 0, v8
  v_cvt_pk_bf16_f32 v9, 0, v9
  v_cvt_pk_bf16_f32 v10, 0, v10
  v_cvt_pk_bf16_f32 v11, 0, v11
  v_cvt_pk_bf16_f32 v12, 0, v12
  v_cvt_pk_bf16_f32 v13, 0, v13
  v_cvt_pk_bf16_f32 v14, 0, v14
  v_cvt_pk_bf16_f32 v15, 0, v15
  v_mul_f32 v20, v8, v19
  v_mul_f32 v21, v9, v19
  v_mul_f32 v22, v10, v19
  v_mul_f32 v23, v11, v19
  v_mul_f32 v24, v12, v19
  v_mul_f32 v25, v13, v19
  v_mul_f32 v26, v14, v19
  v_mul_f32 v27, v15, v19
  v_fma_f32 v8, -v20, v18, v8
  v_fma_f32 v9, -v21, v18, v9
  v_fma_f32 v10, -v22, v18, v10
  v_fma_f32 v11, -v23, v18, v11
  v_fma_f32 v12, -v24, v18, v12
  v_fma_f32 v13, -v25, v18, v13
  v_fma_f32 v14, -v26, v18, v14
  v_fma_f32 v15, -v27, v18, v15
  v_fma_f32 v20, v8, v19, v20
  v_fma_f32 v21, v9, v19, v21
  v_fma_f32 v22, v10, v19, v22
  v_fma_f32 v23, v11, v19, v23
  v_fma_f32 v24, v12, v19, v24
  v_fma_f32 v25, v13, v19, v25
  v_fma_f32 v26, v14, v19, v26
  v_fma_f32 v27, v15, v19, v27
  v_cvt_pk_bf16_f32 v20, 0, v20
  v_cvt_pk_bf16_f32 v21, 0, v21
  v_cvt_pk_bf16_f32 v22, 0, v22
  v_cvt_pk_bf16_f32 v23, 0, v23
  v_cvt_pk_bf16_f32 v24, 0, v24
  v_cvt_pk_bf16_f32 v25, 0, v25
  v_cvt_pk_bf16_f32 v26, 0, v26
  v_cvt_pk_bf16_f32 v27, 0, v27
  v_lshlrev_b32 v16, 5, v0
  v_add_u32 v16, s74, v16
  ds_write_b128 v16, v[20:23]
  ds_write_b128 v16, v[24:27] offset:16
  v_lshlrev_b32 v5, 2, v4
  s_lshl_b32 s57, s5, 8
  s_add_u32 s57, s57, s74
  v_add_u32 v5, s57, v5
  v_mov_b32 v8, 0
  v_mov_b32 v9, 0
  v_mov_b32 v10, 0
  v_mov_b32 v11, 0
  v_mov_b32 v12, 0
  v_mov_b32 v13, 0
  v_mov_b32 v14, 0
  v_mov_b32 v15, 0
  s_waitcnt lgkmcnt(0)
  ds_read_b32 v16, v5 offset:0
  ds_read_b32 v17, v5 offset:32
  ds_read_b32 v18, v5 offset:64
  ds_read_b32 v19, v5 offset:96
  ds_read_b32 v20, v5 offset:128
  ds_read_b32 v21, v5 offset:160
  ds_read_b32 v22, v5 offset:192
  ds_read_b32 v23, v5 offset:224
  s_waitcnt vmcnt(0) lgkmcnt(0)
  buffer_load_dwordx4 v[128:131], v7, s[48:51], s76 offen nt
  s_add_u32 s76, s76, 8192
  buffer_load_dwordx4 v[132:135], v7, s[48:51], s76 offen nt
  s_add_u32 s76, s76, 8192
  buffer_load_dwordx4 v[136:139], v7, s[48:51], s76 offen nt
  s_add_u32 s76, s76, 8192
  buffer_load_dwordx4 v[140:143], v7, s[48:51], s76 offen nt
  s_add_u32 s76, s76, 8192
  buffer_load_dwordx4 v[144:147], v7, s[48:51], s76 offen nt
  s_add_u32 s76, s76, 8192
  buffer_load_dwordx4 v[148:151], v7, s[48:51], s76 offen nt
  s_add_u32 s76, s76, 8192
  buffer_load_dwordx4 v[152:155], v7, s[48:51], s76 offen nt
  s_add_u32 s76, s76, 8192
  buffer_load_dwordx4 v[156:159], v7, s[48:51], s76 offen nt
  s_add_u32 s76, s76, 8192
  v_lshrrev_b32 v24, 16, v16
  v_dot2c_f32_bf16 v8, v24, v32
  v_dot2c_f32_bf16 v9, v16, v32
  v_dot2c_f32_bf16 v10, v24, v33
  v_dot2c_f32_bf16 v11, v16, v33
  v_dot2c_f32_bf16 v12, v24, v34
  v_dot2c_f32_bf16 v13, v16, v34
  v_dot2c_f32_bf16 v14, v24, v35
  v_dot2c_f32_bf16 v15, v16, v35
  v_lshrrev_b32 v24, 16, v17
  v_dot2c_f32_bf16 v8, v24, v36
  v_dot2c_f32_bf16 v9, v17, v36
  v_dot2c_f32_bf16 v10, v24, v37
  v_dot2c_f32_bf16 v11, v17, v37
  v_dot2c_f32_bf16 v12, v24, v38
  v_dot2c_f32_bf16 v13, v17, v38
  v_dot2c_f32_bf16 v14, v24, v39
  v_dot2c_f32_bf16 v15, v17, v39
  v_lshrrev_b32 v24, 16, v18
  v_dot2c_f32_bf16 v8, v24, v40
  v_dot2c_f32_bf16 v9, v18, v40
  v_dot2c_f32_bf16 v10, v24, v41
  v_dot2c_f32_bf16 v11, v18, v41
  v_dot2c_f32_bf16 v12, v24, v42
  v_dot2c_f32_bf16 v13, v18, v42
  v_dot2c_f32_bf16 v14, v24, v43
  v_dot2c_f32_bf16 v15, v18, v43
  v_lshrrev_b32 v24, 16, v19
  v_dot2c_f32_bf16 v8, v24, v44
  v_dot2c_f32_bf16 v9, v19, v44
  v_dot2c_f32_bf16 v10, v24, v45
  v_dot2c_f32_bf16 v11, v19, v45
  v_dot2c_f32_bf16 v12, v24, v46
  v_dot2c_f32_bf16 v13, v19, v46
  v_dot2c_f32_bf16 v14, v24, v47
  v_dot2c_f32_bf16 v15, v19, v47
  v_lshrrev_b32 v24, 16, v20
  v_dot2c_f32_bf16 v8, v24, v48
  v_dot2c_f32_bf16 v9, v20, v48
  v_dot2c_f32_bf16 v10, v24, v49
  v_dot2c_f32_bf16 v11, v20, v49
  v_dot2c_f32_bf16 v12, v24, v50
  v_dot2c_f32_bf16 v13, v20, v50
  v_dot2c_f32_bf16 v14, v24, v51
  v_dot2c_f32_bf16 v15, v20, v51
  v_lshrrev_b32 v24, 16, v21
  v_dot2c_f32_bf16 v8, v24, v52
  v_dot2c_f32_bf16 v9, v21, v52
  v_dot2c_f32_bf16 v10, v24, v53
  v_dot2c_f32_bf16 v11, v21, v53
  v_dot2c_f32_bf16 v12, v24, v54
  v_dot2c_f32_bf16 v13, v21, v54
  v_dot2c_f32_bf16 v14, v24, v55
  v_dot2c_f32_bf16 v15, v21, v55
  v_lshrrev_b32 v24, 16, v22
  v_dot2c_f32_bf16 v8, v24, v56
  v_dot2c_f32_bf16 v9, v22, v56
  v_dot2c_f32_bf16 v10, v24, v57
  v_dot2c_f32_bf16 v11, v22, v57
  v_dot2c_f32_bf16 v12, v24, v58
  v_dot2c_f32_bf16 v13, v22, v58
  v_dot2c_f32_bf16 v14, v24, v59
  v_dot2c_f32_bf16 v15, v22, v59
  v_lshrrev_b32 v24, 16, v23
  v_dot2c_f32_bf16 v8, v24, v60
  v_dot2c_f32_bf16 v9, v23, v60
  v_dot2c_f32_bf16 v10, v24, v61
  v_dot2c_f32_bf16 v11, v23, v61
  v_dot2c_f32_bf16 v12, v24, v62
  v_dot2c_f32_bf16 v13, v23, v62
  v_dot2c_f32_bf16 v14, v24, v63
  v_dot2c_f32_bf16 v15, v23, v63
  v_lshlrev_b32 v185, 5, v0
  v_add_u32 v185, 151040, v185
  v_add_u32 v186, 151040, v3
  s_nop 0
  ds_write_b128 v185, v[8:11]
  ds_write_b128 v185, v[12:15] offset:16
  s_waitcnt lgkmcnt(0)
  ds_read_b32 v16, v186 offset:0
  ds_read_b32 v17, v186 offset:256
  ds_read_b32 v18, v186 offset:512
  ds_read_b32 v19, v186 offset:768
  ds_read_b32 v20, v186 offset:1024
  ds_read_b32 v21, v186 offset:1280
  ds_read_b32 v22, v186 offset:1536
  ds_read_b32 v23, v186 offset:1792
  s_waitcnt lgkmcnt(0)
  v_add_f32 v16, v16, v17
  v_add_f32 v18, v18, v19
  v_add_f32 v20, v20, v21
  v_add_f32 v22, v22, v23
  v_add_f32 v16, v16, v18
  v_add_f32 v20, v20, v22
  v_add_f32 v16, v16, v20
  v_mov_b32 v17, s84
  buffer_store_dwordx2 v[16:17], v187, s[44:47], s58 offen sc0 sc1
  v_lshlrev_b32 v8, 16, v189
  v_and_b32 v9, 0xffff0000, v189
  v_lshlrev_b32 v10, 16, v190
  v_and_b32 v11, 0xffff0000, v190
  v_mov_b32 v5, 131136
  v_mov_b32 v12, s84
  ds_write_b128 v5, v[8:11]
  ds_write_b32 v5, v12 offset:16
  v_mov_b32 v191, 131072
L_wl_h1:
  s_sub_u32 s98, s98, 1
  s_cbranch_scc1 L_end
  s_sleep 8
  ds_read_b32 v1, v191
  s_waitcnt lgkmcnt(0)
  v_readfirstlane_b32 s75, v1
  s_cmp_ge_u32 s75, 22
  s_cbranch_scc0 L_wl_h1
  v_mov_b32 v5, 0
  s_branch L_h_poll1
L_h_poll:
  s_sub_u32 s98, s98, 1
  s_cbranch_scc1 L_end
  s_sleep 64
L_h_poll1:
  buffer_load_dword v6, v5, s[68:71], 0 offen sc0 sc1
  s_waitcnt vmcnt(0)
  v_readfirstlane_b32 s75, v6
  s_cmp_eq_u32 s75, 1
  s_cbranch_scc0 L_h_poll
  s_lshl_b32 s83, s2, 7
  s_mov_b64 exec, 1
  buffer_store_dword v12, v5, s[44:47], s83 offen sc0 sc1
  s_mov_b64 exec, -1
  v_mov_b32 v8, s4
  v_and_b32 v9, 7, v0
  v_subrev_u32 v10, 16, v0
  v_and_b32 v10, 31, v10
  v_mov_b32 v11, s5
  v_cmp_le_u32 vcc, 16, v0
  s_nop 1
  v_cndmask_b32 v8, v8, v10, vcc
  v_cndmask_b32 v9, v9, v11, vcc
  v_lshrrev_b32 v10, 2, v8
  v_and_b32 v11, 3, v8
  v_lshl_add_u32 v10, v11, 3, v10
  v_lshl_add_u32 v10, v9, 5, v10
  v_lshlrev_b32 v10, 7, v10
  v_and_b32 v13, 31, v0
  s_and_b32 s57, s2, 7
  v_lshlrev_b32 v11, 3, v13
  v_add_u32 v11, s57, v11
  v_lshlrev_b32 v11, 7, v11
  v_lshlrev_b32 v13, 3, v0
  v_mov_b32 v191, 131072
L_wl_hq:
  s_sub_u32 s98, s98, 1
  s_cbranch_scc1 L_end
  s_sleep 8
  ds_read_b32 v1, v191
  s_waitcnt lgkmcnt(0)
  v_readfirstlane_b32 s75, v1
  s_cmp_ge_u32 s75, 32
  s_cbranch_scc0 L_wl_hq
  s_branch L_h_epoll1
L_h_epoll:
  s_sub_u32 s98, s98, 1
  s_cbranch_scc1 L_end
  s_sleep 64
L_h_epoll1:
  buffer_load_dword v16, v10, s[44:47], 0 offen sc0 sc1
  buffer_load_dword v17, v11, s[44:47], 0 offen sc0 sc1
  s_waitcnt vmcnt(0)
  v_max_u32 v18, v16, v17
  v_cmp_eq_u32 vcc, -1, v18
  s_cbranch_vccnz L_h_epoll
  v_add_u32 v5, 153600, v3
  ds_write_b32 v5, v16
  v_readlane_b32 s60, v16, 0
  v_readlane_b32 s61, v16, 1
  v_readlane_b32 s62, v16, 2
  v_readlane_b32 s63, v16, 3
  v_readlane_b32 s64, v16, 4
  v_readlane_b32 s65, v16, 5
  v_readlane_b32 s66, v16, 6
  v_readlane_b32 s67, v16, 7
  s_lshl_b32 s58, s4, 12
  s_add_u32 s58, s58, 851968
  s_branch L_h_hpoll1
L_h_hpoll:
  s_sub_u32 s98, s98, 1
  s_cbranch_scc1 L_end
  s_sleep 64
L_h_hpoll1:
  buffer_load_dwordx2 v[64:65], v187, s[44:47], s58 offen offset:0 sc0 sc1 nt
  buffer_load_dwordx2 v[66:67], v187, s[44:47], s58 offen offset:512 sc0 sc1 nt
  buffer_load_dwordx2 v[68:69], v187, s[44:47], s58 offen offset:1024 sc0 sc1 nt
  buffer_load_dwordx2 v[70:71], v187, s[44:47], s58 offen offset:1536 sc0 sc1 nt
  buffer_load_dwordx2 v[72:73], v187, s[44:47], s58 offen offset:2048 sc0 sc1 nt
  buffer_load_dwordx2 v[74:75], v187, s[44:47], s58 offen offset:2560 sc0 sc1 nt
  buffer_load_dwordx2 v[76:77], v187, s[44:47], s58 offen offset:3072 sc0 sc1 nt
  buffer_load_dwordx2 v[78:79], v187, s[44:47], s58 offen offset:3584 sc0 sc1 nt
  s_waitcnt vmcnt(0)
  v_xor_b32 v48, s60, v65
  v_xor_b32 v49, s61, v67
  v_or_b32 v48, v48, v49
  v_xor_b32 v49, s62, v69
  v_or_b32 v48, v48, v49
  v_xor_b32 v49, s63, v71
  v_or_b32 v48, v48, v49
  v_xor_b32 v49, s64, v73
  v_or_b32 v48, v48, v49
  v_xor_b32 v49, s65, v75
  v_or_b32 v48, v48, v49
  v_xor_b32 v49, s66, v77
  v_or_b32 v48, v48, v49
  v_xor_b32 v49, s67, v79
  v_or_b32 v48, v48, v49
  v_cmp_ne_u32 vcc, 0, v48
  s_cbranch_vccnz L_h_hpoll
L_h_hdone:
  v_add_f32 v64, v64, v66
  v_add_f32 v68, v68, v70
  v_add_f32 v72, v72, v74
  v_add_f32 v76, v76, v78
  v_add_f32 v64, v64, v68
  v_add_f32 v72, v72, v76
  v_add_f32 v64, v64, v72
  v_cvt_pk_bf16_f32 v64, 0, v64
  v_lshlrev_b32 v65, 16, v188
  v_add_f32 v64, v64, v65
  v_cvt_pk_bf16_f32 v64, 0, v64
  v_cmp_lt_f32 vcc, 0, v64
  s_nop 1
  v_cndmask_b32 v64, 0, v64, vcc
  v_mul_f32 v64, v64, v64
  v_cvt_pk_bf16_f32 v64, 0, v64
  v_add_u32 v65, 153088, v3
  ds_write_b32 v65, v64
  v_lshlrev_b32 v65, 2, v4
  v_add_u32 v65, 153088, v65
  v_mov_b32 v40, 0
  v_mov_b32 v41, 0
  v_mov_b32 v42, 0
  v_mov_b32 v43, 0
  v_mov_b32 v44, 0
  v_mov_b32 v45, 0
  v_mov_b32 v46, 0
  v_mov_b32 v47, 0
  s_waitcnt lgkmcnt(0)
  ds_read_b32 v48, v65 offset:0
  ds_read_b32 v49, v65 offset:32
  ds_read_b32 v50, v65 offset:64
  ds_read_b32 v51, v65 offset:96
  ds_read_b32 v52, v65 offset:128
  ds_read_b32 v53, v65 offset:160
  ds_read_b32 v54, v65 offset:192
  ds_read_b32 v55, v65 offset:224
  s_waitcnt lgkmcnt(0)
  v_lshrrev_b32 v56, 16, v48
  v_dot2c_f32_bf16 v40, v56, v128
  v_dot2c_f32_bf16 v41, v48, v128
  v_dot2c_f32_bf16 v42, v56, v129
  v_dot2c_f32_bf16 v43, v48, v129
  v_dot2c_f32_bf16 v44, v56, v130
  v_dot2c_f32_bf16 v45, v48, v130
  v_dot2c_f32_bf16 v46, v56, v131
  v_dot2c_f32_bf16 v47, v48, v131
  v_lshrrev_b32 v56, 16, v49
  v_dot2c_f32_bf16 v40, v56, v132
  v_dot2c_f32_bf16 v41, v49, v132
  v_dot2c_f32_bf16 v42, v56, v133
  v_dot2c_f32_bf16 v43, v49, v133
  v_dot2c_f32_bf16 v44, v56, v134
  v_dot2c_f32_bf16 v45, v49, v134
  v_dot2c_f32_bf16 v46, v56, v135
  v_dot2c_f32_bf16 v47, v49, v135
  v_lshrrev_b32 v56, 16, v50
  v_dot2c_f32_bf16 v40, v56, v136
  v_dot2c_f32_bf16 v41, v50, v136
  v_dot2c_f32_bf16 v42, v56, v137
  v_dot2c_f32_bf16 v43, v50, v137
  v_dot2c_f32_bf16 v44, v56, v138
  v_dot2c_f32_bf16 v45, v50, v138
  v_dot2c_f32_bf16 v46, v56, v139
  v_dot2c_f32_bf16 v47, v50, v139
  v_lshrrev_b32 v56, 16, v51
  v_dot2c_f32_bf16 v40, v56, v140
  v_dot2c_f32_bf16 v41, v51, v140
  v_dot2c_f32_bf16 v42, v56, v141
  v_dot2c_f32_bf16 v43, v51, v141
  v_dot2c_f32_bf16 v44, v56, v142
  v_dot2c_f32_bf16 v45, v51, v142
  v_dot2c_f32_bf16 v46, v56, v143
  v_dot2c_f32_bf16 v47, v51, v143
  v_lshrrev_b32 v56, 16, v52
  v_dot2c_f32_bf16 v40, v56, v144
  v_dot2c_f32_bf16 v41, v52, v144
  v_dot2c_f32_bf16 v42, v56, v145
  v_dot2c_f32_bf16 v43, v52, v145
  v_dot2c_f32_bf16 v44, v56, v146
  v_dot2c_f32_bf16 v45, v52, v146
  v_dot2c_f32_bf16 v46, v56, v147
  v_dot2c_f32_bf16 v47, v52, v147
  v_lshrrev_b32 v56, 16, v53
  v_dot2c_f32_bf16 v40, v56, v148
  v_dot2c_f32_bf16 v41, v53, v148
  v_dot2c_f32_bf16 v42, v56, v149
  v_dot2c_f32_bf16 v43, v53, v149
  v_dot2c_f32_bf16 v44, v56, v150
  v_dot2c_f32_bf16 v45, v53, v150
  v_dot2c_f32_bf16 v46, v56, v151
  v_dot2c_f32_bf16 v47, v53, v151
  v_lshrrev_b32 v56, 16, v54
  v_dot2c_f32_bf16 v40, v56, v152
  v_dot2c_f32_bf16 v41, v54, v152
  v_dot2c_f32_bf16 v42, v56, v153
  v_dot2c_f32_bf16 v43, v54, v153
  v_dot2c_f32_bf16 v44, v56, v154
  v_dot2c_f32_bf16 v45, v54, v154
  v_dot2c_f32_bf16 v46, v56, v155
  v_dot2c_f32_bf16 v47, v54, v155
  v_lshrrev_b32 v56, 16, v55
  v_dot2c_f32_bf16 v40, v56, v156
  v_dot2c_f32_bf16 v41, v55, v156
  v_dot2c_f32_bf16 v42, v56, v157
  v_dot2c_f32_bf16 v43, v55, v157
  v_dot2c_f32_bf16 v44, v56, v158
  v_dot2c_f32_bf16 v45, v55, v158
  v_dot2c_f32_bf16 v46, v56, v159
  v_dot2c_f32_bf16 v47, v55, v159
  s_nop 2
  ds_write_b128 v185, v[40:43]
  ds_write_b128 v185, v[44:47] offset:16
  s_waitcnt lgkmcnt(0)
  ds_read_b32 v48, v186 offset:0
  ds_read_b32 v49, v186 offset:256
  ds_read_b32 v50, v186 offset:512
  ds_read_b32 v51, v186 offset:768
  ds_read_b32 v52, v186 offset:1024
  ds_read_b32 v53, v186 offset:1280
  ds_read_b32 v54, v186 offset:1536
  ds_read_b32 v55, v186 offset:1792
  s_waitcnt lgkmcnt(0)
  v_add_f32 v48, v48, v49
  v_add_f32 v50, v50, v51
  v_add_f32 v52, v52, v53
  v_add_f32 v54, v54, v55
  v_add_f32 v48, v48, v50
  v_add_f32 v52, v52, v54
  v_add_f32 v48, v48, v52
  v_add_u32 v49, 153344, v3
  ds_write_b32 v49, v48
  v_mov_b32 v191, 131072
  s_mov_b32 s76, 0
  s_mov_b32 s79, 0
  v_mov_b32 v15, s84
  s_lshr_b32 s64, s2, 3
  s_mul_i32 s65, s64, 512
  s_add_u32 s65, s65, 1408
  s_cmp_lt_u32 s64, 12
  s_cselect_b32 s66, 0, 2
  s_lshl_b32 s67, s64, 10
  v_and_b32 v36, 7, v0
  v_lshlrev_b32 v36, 7, v36
  v_mov_b32 v37, -1
L_h_ev:
  s_sub_u32 s98, s98, 1
  s_cbranch_scc1 L_end
  s_sleep 2
  ds_read_b128 v[32:35], v191
  s_waitcnt lgkmcnt(0)
  v_readfirstlane_b32 s75, v32
  v_readfirstlane_b32 s77, v35
  s_cmp_lg_u32 s79, 0
  s_cbranch_scc1 L_h_ev2
  s_cmp_ge_u32 s77, 4
  s_cbranch_scc1 L_h_mid
  s_branch L_h_ev3
L_h_ev2:
  s_cmp_ge_u32 s75, 248
  s_cbranch_scc1 L_h_exit
L_h_ev3:
  s_cmp_ge_u32 s75, s76
  s_cbranch_scc0 L_h_ev
  s_add_u32 s76, s75, 1
  v_mov_b32 v14, s75
  v_mov_b32 v5, 0
  s_mov_b64 exec, 1
  buffer_store_dwordx2 v[14:15], v5, s[44:47], s89 offen
  s_mov_b64 exec, -1
  buffer_load_dwordx2 v[32:33], v13, s[44:47], s88 offen nt
  s_waitcnt vmcnt(0)
  v_mov_b32 v38, v32
  v_subrev_u32 v32, s75, v32
  v_cmp_eq_u32 s[60:61], v33, v17
  v_add_u32 v33, 12, v32
  v_cmp_gt_u32 vcc, 25, v33
  s_and_b64 vcc, vcc, s[60:61]
  s_bcnt1_i32_b32 s78, vcc_lo
  s_flbit_i32_b32 s63, s61
  s_sub_u32 s63, 63, s63
  s_cmp_lg_u32 s61, 0
  s_cselect_b32 s59, 1, 0
  v_cndmask_b32 v32, 0, v32, vcc
  s_nop 1
  v_add_u32_dpp v32, v32, v32 row_ror:1 row_mask:0xf bank_mask:0xf
  s_nop 1
  v_add_u32_dpp v32, v32, v32 row_ror:2 row_mask:0xf bank_mask:0xf
  s_nop 1
  v_add_u32_dpp v32, v32, v32 row_ror:4 row_mask:0xf bank_mask:0xf
  s_nop 1
  v_add_u32_dpp v32, v32, v32 row_ror:8 row_mask:0xf bank_mask:0xf
  s_nop 0
  v_readlane_b32 s60, v32, 0
  v_readlane_b32 s61, v32, 16
  s_add_u32 s60, s60, s61
  s_and_b32 s63, s63, 63
  s_lshl_b32 s58, s75, 5
  s_add_u32 s58, s58, s60
  v_readlane_b32 s63, v38, s63
  s_lshl_b32 s60, s60, 1
  s_mul_i32 s63, s63, s59
  s_cmp_eq_u32 s78, 32
  s_cselect_b32 s63, s63, 0
  s_add_u32 s60, s60, s63
  s_mul_i32 s61, s78, 1
  s_add_u32 s60, s60, s61
  s_mov_b32 s62, 0
  s_mul_i32 s61, s78, -4
  s_cmp_le_i32 s60, s61
  s_cselect_b32 s62, 1, s62
  s_mul_i32 s61, s78, 3
  s_cmp_ge_i32 s60, s61
  s_cselect_b32 s62, 2, s62
  s_mul_i32 s61, s78, 6
  s_cmp_ge_i32 s60, s61
  s_cselect_b32 s62, 3, s62
  s_cmp_lt_u32 s78, 8
  s_cselect_b32 s62, 0, s62
  v_mov_b32 v32, s62
  ds_write_b32 v191, v32 offset:4
  s_cmp_eq_u32 s66, 2
  s_cbranch_scc1 L_h_ev
  s_cmp_lg_u32 s78, 32
  s_cbranch_scc1 L_h_ev
  s_add_u32 s60, s58, 320
  s_cmp_lt_u32 s60, s65
  s_cbranch_scc1 L_h_ev
  s_cmp_lg_u32 s66, 0
  s_cbranch_scc1 L_h_x1
  s_cmp_lt_u32 s58, s65
  s_cbranch_scc1 L_h_x1
  s_mov_b64 exec, 1
  buffer_store_dword v15, v5, s[44:47], s83 offen offset:64 sc0 sc1
  s_mov_b32 s66, 1
L_h_x1:
  s_mov_b64 exec, 0xffff
  buffer_load_dword v32, v36, s[44:47], s67 offen offset:64 sc0 sc1
  v_mov_b32 v33, s58
  s_add_u32 s60, s65, 384
  s_cmp_ge_u32 s58, s60
  s_cselect_b32 s60, 0, -1
  s_waitcnt vmcnt(0)
  v_and_b32 v32, s60, v32
  v_cmp_ne_u32 vcc, -1, v32
  v_min_u32 v33, v33, v37
  s_nop 0
  v_cndmask_b32 v37, v37, v33, vcc
  s_cmp_lg_u32 vcc_lo, 0xffff
  s_cbranch_scc1 L_h_x2
  s_and_b32 s60, s2, 7
  v_mov_b32 v32, v37
  s_nop 0
  v_readlane_b32 s61, v37, s60
  s_nop 1
  v_add_u32_dpp v32, v32, v32 row_ror:1 row_mask:0xf bank_mask:0xf
  s_nop 1
  v_add_u32_dpp v32, v32, v32 row_ror:2 row_mask:0xf bank_mask:0xf
  s_nop 1
  v_add_u32_dpp v32, v32, v32 row_ror:4 row_mask:0xf bank_mask:0xf
  s_nop 0
  v_readlane_b32 s60, v32, 0
  s_lshl_b32 s61, s61, 3
  s_sub_u32 s60, s61, s60
  s_mul_i32 s60, s60, 3
  s_ashr_i32 s60, s60, 3
  v_mov_b32 v14, s60
  s_mov_b64 exec, 1
  buffer_store_dwordx2 v[14:15], v5, s[44:47], s89 offen offset:256
  s_mov_b32 s66, 2
L_h_x2:
  s_mov_b64 exec, -1
  s_branch L_h_ev
L_h_mid:
  v_mov_b32 v5, 131200
  ds_read_b128 v[20:23], v5
  ds_read_b128 v[24:27], v5 offset:16
  s_mov_b32 s60, 0x3fb8aa3b
  v_mov_b32 v5, 0
  v_mov_b32 v29, s84
  v_mov_b32 v31, s84
  s_waitcnt lgkmcnt(0)
  v_max_f32 v28, v20, v22
  v_max3_f32 v28, v24, v26, v28
  v_sub_f32 v20, v20, v28
  v_sub_f32 v22, v22, v28
  v_sub_f32 v24, v24, v28
  v_sub_f32 v26, v26, v28
  v_mul_f32 v20, s60, v20
  v_mul_f32 v22, s60, v22
  v_mul_f32 v24, s60, v24
  v_mul_f32 v26, s60, v26
  v_exp_f32 v20, v20
  v_exp_f32 v22, v22
  v_exp_f32 v24, v24
  v_exp_f32 v26, v26
  s_nop 0
  v_mul_f32 v30, v20, v21
  v_fmac_f32 v30, v22, v23
  v_fmac_f32 v30, v24, v25
  v_fmac_f32 v30, v26, v27
  s_mov_b64 exec, 1
  buffer_store_dwordx4 v[28:31], v5, s[44:47], s99 offen
  s_mov_b64 exec, 0xffff
  v_and_b32 v18, 7, v0
  v_lshlrev_b32 v18, 4, v18
  s_lshl_b32 s61, s4, 7
  s_add_u32 s61, s61, 36864
  s_mov_b32 s62, 0
  s_mov_b32 s63, 1
L_h_mpoll:
  s_sub_u32 s98, s98, 1
  s_cbranch_scc1 L_end
  s_sleep 1
  s_add_u32 s62, s62, 1
  s_and_b32 s57, s62, 7
  s_cbranch_scc0 L_h_mslow
  buffer_load_dwordx4 v[20:23], v18, s[44:47], s61 offen nt
  s_branch L_h_mw
L_h_mslow:
  s_cmp_eq_u32 s63, 0
  s_cbranch_scc1 L_h_mo1
  s_mov_b64 exec, 1
  buffer_store_dwordx4 v[28:31], v5, s[44:47], s83 offen offset:16 sc0 sc1
  s_mov_b64 exec, 0xffff
  s_mov_b32 s63, 0
L_h_mo1:
  buffer_load_dwordx4 v[20:23], v10, s[44:47], 0 offen offset:16 sc0 sc1
L_h_mw:
  s_waitcnt vmcnt(0)
  v_xor_b32 v24, v21, v16
  v_xor_b32 v25, v23, v16
  v_or_b32 v24, v24, v25
  v_cmp_ne_u32 vcc, 0, v24
  s_cbranch_vccnz L_h_mpoll
  v_mov_b32 v24, v20
  s_nop 1
  v_max_f32_dpp v24, v24, v24 row_ror:1 row_mask:0xf bank_mask:0xf
  s_nop 1
  v_max_f32_dpp v24, v24, v24 row_ror:2 row_mask:0xf bank_mask:0xf
  s_nop 1
  v_max_f32_dpp v24, v24, v24 row_ror:4 row_mask:0xf bank_mask:0xf
  v_sub_f32 v20, v20, v24
  v_mul_f32 v20, s60, v20
  v_exp_f32 v20, v20
  s_nop 0
  v_mul_f32 v20, v20, v22
  s_nop 1
  v_add_f32_dpp v20, v20, v20 row_ror:1 row_mask:0xf bank_mask:0xf
  s_nop 1
  v_add_f32_dpp v20, v20, v20 row_ror:2 row_mask:0xf bank_mask:0xf
  s_nop 1
  v_add_f32_dpp v20, v20, v20 row_ror:4 row_mask:0xf bank_mask:0xf
  v_rcp_f32 v21, v20
  s_nop 0
  v_fma_f32 v22, -v20, v21, 1.0
  v_fma_f32 v26, v22, v21, v21
  v_mov_b32 v25, v24
  v_mov_b32 v24, 1
  v_mov_b32 v27, 0
  v_mov_b32 v5, 131088
  s_mov_b64 exec, 1
  ds_write_b128 v5, v[24:27]
  s_cmp_eq_u32 s63, 0
  s_cbranch_scc1 L_h_mo2
  v_mov_b32 v5, 0
  buffer_store_dwordx4 v[28:31], v5, s[44:47], s83 offen offset:16 sc0 sc1
L_h_mo2:
  s_mov_b64 exec, -1
  s_mov_b32 s79, 1
  s_branch L_h_ev
L_h_exit:
  s_waitcnt vmcnt(0) lgkmcnt(0)
L_end:
  s_endpgm
.section .rodata,"a"
.p2align 6
.amdhsa_kernel parallel_sum__mha_block_cached__dense_activation_squared_relu__decode_kernel
  .amdhsa_next_free_vgpr 192
  .amdhsa_next_free_sgpr 102
  .amdhsa_accum_offset 192
  .amdhsa_group_segment_fixed_size 0
  .amdhsa_kernarg_size 104
  .amdhsa_user_sgpr_count 2
  .amdhsa_user_sgpr_kernarg_segment_ptr 1
  .amdhsa_system_sgpr_workgroup_id_x 1
  .amdhsa_float_denorm_mode_32 3
.end_amdhsa_kernel
```
